```python
import torch

def _softmax(x, axis=-1):
    return torch.softmax(x, dim=axis)
def _gelu(x):
    return torch.nn.functional.gelu(x, approximate="tanh")
def _silu(x):
    return torch.nn.functional.silu(x)
def _sigmoid(x):
    return torch.sigmoid(x)
def _layernorm(x, axis=-1, eps=1e-5):
    m = x.mean(dim=axis, keepdim=True)
    v = x.var(dim=axis, keepdim=True, unbiased=False)
    return (x - m) / torch.sqrt(v + eps)
def _scatter_add(tgt, idx, src, axis=0):
    return tgt.clone().index_add_(axis, idx, src)
def _segment_sum(src, seg, n):
    out = torch.zeros((n,) + src.shape[1:], dtype=src.dtype)
    return out.index_add_(0, seg, src)
def _pad(x, pw):
    flat = tuple(v for pair in reversed(pw) for v in pair)
    return torch.nn.functional.pad(x, flat)

kernel_name = 'concat_heads__ssm_conv_s4__ssm_conv_h3__prompt'

def setup_inputs():

    _w = (lambda a: (lambda t: t.to(torch.bfloat16) if t.is_floating_point() else t)(torch.as_tensor(a)))
    def _A_setup():
        B, L, D, N = 1, 2048, 576, 128
        A_re = -(lambda _x: torch.exp(torch.as_tensor(_x)))((lambda *s: torch.randn(*s, dtype=torch.bfloat16) * 6.4)(D, N))
        A_im = torch.pi * (lambda *s: torch.randn(*s, dtype=torch.bfloat16) * 0.05)(D, N)
        B_re = (lambda *s: torch.randn(*s, dtype=torch.bfloat16) * 0.1)(D, N)
        B_im = (lambda *s: torch.randn(*s, dtype=torch.bfloat16) * 0.1)(D, N)
        C_re = (lambda *s: torch.randn(*s, dtype=torch.bfloat16) * 0.1)(D, N)
        C_im = (lambda *s: torch.randn(*s, dtype=torch.bfloat16) * 0.1)(D, N)
        log_dt = (lambda *s: torch.randn(*s, dtype=torch.bfloat16) * 0.05)(D) * 0.5 - 4.0
        Dskip = (lambda *s: torch.randn(*s, dtype=torch.bfloat16) * 0.05)(D)
        return {
            "u": _w((lambda *s: torch.randn(*s, dtype=torch.bfloat16) * 0.05)(B, L, D)),
            "A_re": _w(A_re),
            "A_im": _w(A_im),
            "B_re": _w(B_re),
            "B_im": _w(B_im),
            "C_re": _w(C_re),
            "C_im": _w(C_im),
            "log_dt": _w(log_dt),
            "Dskip": _w(Dskip),
        }
    _A_in = _A_setup()

    def _B_setup():
        B, S, D = 1, 2048, 576
        ks = 4
        return {
            "q": _w((lambda *s: torch.randn(*s, dtype=torch.bfloat16) * 0.05)(B, S, D)),
            "k": _w((lambda *s: torch.randn(*s, dtype=torch.bfloat16) * 0.4)(B, S, D)),
            "v": _w((lambda *s: torch.randn(*s, dtype=torch.bfloat16) * 0.4)(B, S, D)),
            "shift_k": _w((lambda *s: torch.randn(*s, dtype=torch.bfloat16) * 0.4)(D, ks) * 0.5),
            "ssm_k": _w((lambda *s: torch.randn(*s, dtype=torch.bfloat16) * 0.4)(D, S) * (1.0 / S ** 0.5)),
            "ssm_D": _w((lambda *s: torch.randn(*s, dtype=torch.bfloat16) * 0.4)(D)),
        }
    _B_in = _B_setup()

    return {
        "A_u": _A_in["u"],
        "A_A_re": _A_in["A_re"],
        "A_A_im": _A_in["A_im"],
        "A_B_re": _A_in["B_re"],
        "A_B_im": _A_in["B_im"],
        "A_C_re": _A_in["C_re"],
        "A_C_im": _A_in["C_im"],
        "A_log_dt": _A_in["log_dt"],
        "A_Dskip": _A_in["Dskip"],
        "B_q": _B_in["q"],
        "B_k": _B_in["k"],
        "B_v": _B_in["v"],
        "B_shift_k": _B_in["shift_k"],
        "B_ssm_k": _B_in["ssm_k"],
        "B_ssm_D": _B_in["ssm_D"],
    }

def reference(A_u, A_A_re, A_A_im, A_B_re, A_B_im, A_C_re, A_C_im, A_log_dt, A_Dskip, B_q, B_k, B_v, B_shift_k, B_ssm_k, B_ssm_D):
    def _A_ref(u, A_re, A_im, B_re, B_im, C_re, C_im, log_dt, Dskip):
        Bsz, L, D = u.shape
        dt = torch.exp(log_dt)[:, None]
        A = A_re + 1j * A_im
        Bc = B_re + 1j * B_im
        Cc = C_re + 1j * C_im
        logdA = dt * A
        dB = dt * Bc
        l = (lambda x, dt: x.to(dt))(torch.arange(L), A_re.dtype)
        P = torch.exp(logdA[:, :, None] * l[None, None, :])
        K = torch.einsum("dn,dnl,dn->dl", Cc, P, dB).real
        L2 = 2 * L
        Kp = _pad(K, ((0, 0), (0, L)))
        up = (lambda x, *d: x.permute(*d))(u, 0, 2, 1)
        up = _pad(up, ((0, 0), (0, 0), (0, L)))
        Kf = (lambda x, axes=(-2,-1): torch.fft.rfft2(x.float(), dim=axes))(Kp[:, None, :], axes=(-2, -1))
        Uf = (lambda x, axes=(-2,-1): torch.fft.rfft2(x.float(), dim=axes))(up[:, :, None, :], axes=(-2, -1))
        Yf = Uf * Kf[None, :, :, :]
        y = (lambda x, s, axes=(-2,-1): torch.fft.irfft2(x, s=s, dim=axes).to(torch.bfloat16))(Yf, (1, L2), axes=(-2, -1))[:, :, 0, :L]
        y = (lambda x, *d: x.permute(*d))(y, 0, 2, 1) + u * Dskip[None, None, :]
        return y

    def _B_ref(q, k, v, shift_k, ssm_k, ssm_D):
        B, S, D = q.shape
        ks = shift_k.shape[-1]
        k_pad = _pad(k, ((0, 0), (ks - 1, 0), (0, 0)))
        k_shift = torch.zeros_like(k)
        for t in range(ks):
            k_shift = k_shift + k_pad[:, t:t + S, :] * shift_k[:, ks - 1 - t][None, None, :]
        kv = k_shift * v
        L = 2 * S
        kv_pad = _pad(kv, ((0, 0), (0, S), (0, 0)))
        kf_pad = _pad(ssm_k, ((0, 0), (0, S)))
        kv_f = (lambda x, axes=(-2,-1): torch.fft.rfft2(x.float(), dim=axes))(kv_pad[:, None, :, :], axes=(1, 2))
        kf_f = (lambda x, axes=(-2,-1): torch.fft.rfft2(x.float(), dim=axes))(kf_pad[:, None, :], axes=(1, 2))
        kf_f = (lambda x, *d: x.permute(*d))(kf_f, 1, 2, 0)
        y_f = kv_f * kf_f[None, :, :, :]
        y = (lambda x, s, axes=(-2,-1): torch.fft.irfft2(x, s=s, dim=axes).to(torch.bfloat16))(y_f, (1, L), axes=(1, 2))[:, 0, :S, :]
        y = y + kv * ssm_D[None, None, :]
        return q * y

    a = _A_ref(A_u, A_A_re, A_A_im, A_B_re, A_B_im, A_C_re, A_C_im, A_log_dt, A_Dskip)
    b = _B_ref(B_q, B_k, B_v, B_shift_k, B_ssm_k, B_ssm_D)
    return torch.concatenate([a, b], axis=-1)
```

```asm
; @launch grid=(256,1,1) block=(512,1,1) lds=126016
.amdgcn_target "amdgcn-amd-amdhsa--gfx950"
.text
.globl concat_heads__ssm_conv_s4__ssm_conv_h3__prompt_kernel
.p2align 8
.type concat_heads__ssm_conv_s4__ssm_conv_h3__prompt_kernel,@function
concat_heads__ssm_conv_s4__ssm_conv_h3__prompt_kernel:
L_entry:
    s_load_dwordx16 s[16:31], s[0:1], 0
    s_load_dwordx16 s[32:47], s[0:1], 64
    s_load_dwordx4 s[48:51], s[0:1], 128
    s_cmp_ge_u32 s2, 256
    s_cbranch_scc1 L_end
    v_lshrrev_b32 v2, 6, v0
    v_and_b32 v1, 63, v0
    s_lshr_b32 s8, s2, 3
    v_readfirstlane_b32 s6, v2
    s_and_b32 s7, s2, 7
    s_and_b32 s11, s8, 15
    s_mov_b32 s10, s7
    s_and_b32 s14, s6, 3
    s_lshr_b32 s15, s6, 2
    s_cmp_lg_u32 s6, 7
    s_cbranch_scc1 L_nopf
    s_getpc_b64 s[4:5]
L_pc:
    s_sub_u32 s4, s4, L_pc-L_entry
    s_subb_u32 s5, s5, 0
    s_lshl_b32 s3, s11, 11
    v_lshl_add_u32 v2, v1, 7, s3
    v_min_u32 v2, L_end-L_entry, v2
    s_mov_b64 exec, 0xffff
    global_load_dword v4, v2, s[4:5]
    s_mov_b64 exec, -1
L_nopf:
    s_cmp_lt_u32 s8, 16
    s_cbranch_scc1 L_B0
    s_mov_b32 s10, 8
    s_cmp_eq_u32 s7, 0
    s_cbranch_scc1 L_B0
    s_cmp_eq_u32 s7, 7
    s_cbranch_scc1 L_end
    s_sub_u32 s12, s7, 1
    s_lshl_b32 s9, s12, 4
    s_add_u32 s9, s9, s11
    s_lshr_b32 s8, s14, 1
    s_add_u32 s8, s8, 4
    s_and_b32 s13, s6, 1
    s_lshl_b32 s13, s13, 7
    s_cmp_eq_u32 s15, 0
    s_cselect_b32 s8, s6, s8
    s_cselect_b32 s13, 0, s13
    s_mul_i32 s10, s9, 6
    s_add_u32 s10, s10, s8
    s_lshl_b32 s3, s10, 8
    s_add_u32 s3, s3, s13
    v_lshrrev_b32 v6, s15, v1
    v_lshl_add_u32 v6, v6, 2, s3
    s_lshl_b32 s3, s10, 1
    v_mov_b32 v2, s3
    s_mul_i32 s12, s12, 192
    s_and_b32 s12, s12, -128
    s_lshl_b32 s3, s11, 2
    s_add_u32 s3, s3, s14
    s_mul_i32 s3, s3, 36864
    s_add_u32 s3, s3, s12
    v_lshrrev_b32 v5, 1, v1
    v_mul_u32_u24 v5, 1152, v5
    v_and_b32 v3, 1, v1
    v_lshl_add_u32 v5, v3, 7, v5
    v_add_u32_e64 v5, s3, v5
    s_waitcnt lgkmcnt(0)
    global_load_ushort v14, v2, s[30:31]
    global_load_dword v8, v6, s[18:19]
    global_load_dword v9, v6, s[20:21]
    global_load_dword v10, v6, s[22:23]
    global_load_dword v11, v6, s[24:25]
    global_load_dword v12, v6, s[26:27]
    global_load_dword v13, v6, s[28:29]
    global_load_ushort v15, v2, s[32:33]
    v_mov_b32 v64, 0
    v_mov_b32 v65, 0
    v_mov_b32 v66, 0
    v_mov_b32 v67, 0
    v_mov_b32 v2, 121856
    ds_write_b128 v2, v[64:67]
    ds_write_b64 v2, v[64:65] offset:16
    s_waitcnt lgkmcnt(0)
    s_barrier
    s_cmp_eq_u32 s15, 0
    s_cbranch_scc1 L_A1
    global_load_dword v4, v5, s[16:17]
    s_branch L_A1
L_B0:
    s_lshl_b32 s12, s11, 3
    s_add_u32 s12, s12, s6
    s_mul_i32 s12, s12, 18432
    s_lshl_b32 s13, s10, 7
    s_add_u32 s12, s12, s13
    v_lshrrev_b32 v2, 3, v1
    v_mul_u32_u24 v2, 1152, v2
    v_and_b32 v3, 7, v1
    v_lshl_add_u32 v2, v3, 4, v2
    v_add_u32 v6, s12, v2
    v_subrev_u32 v7, 9216, v6
    s_mul_i32 s13, s6, 5120
    s_add_u32 s13, s13, 66560
    s_movk_i32 s3, 8192
    s_nop 0
    s_add_u32 m0, s13, 1024
    s_mov_b32 s54, 2359296
    s_mov_b32 s55, 0x20000
    s_mov_b32 s62, 2359296
    s_mov_b32 s63, 0x20000
    v_and_b32 v2, 31, v1
    s_lshl_b32 s12, s10, 9
    v_lshl_add_u32 v2, v2, 4, s12
    s_lshl_b32 s66, s10, 18
    s_lshl_b32 s12, s11, 10
    s_add_u32 s66, s66, s12
    v_mov_b32 v8, 125952
    v_mov_b32 v9, 0
    ds_write_b32 v8, v9 offset:8
    s_waitcnt lgkmcnt(0)
    s_mov_b32 s52, s36
    s_mov_b32 s53, s37
    s_mov_b32 s60, s38
    s_mov_b32 s61, s39
    s_nop 0
    buffer_load_dwordx4 v6, s[52:55], 0 offen lds
    buffer_load_dwordx4 v6, s[52:55], s3 offen offset:1024 lds
    s_add_u32 m0, s13, 3072
    global_load_dwordx4 v[8:11], v2, s[40:41]
    buffer_load_dwordx4 v6, s[60:63], 0 offen lds
    buffer_load_dwordx4 v6, s[60:63], s3 offen offset:1024 lds
    s_mov_b32 m0, s13
    s_mov_b32 exec_lo, 0
    s_mov_b32 exec_hi, 0xffffff00
    buffer_load_dwordx4 v7, s[52:55], 0 offen lds
    s_mov_b64 exec, -1
    s_lshl_b32 s9, s10, 4
    s_add_u32 s9, s9, s11
    s_lshl_b32 s12, s9, 2
    s_add_u32 s12, s12, s14
    s_lshl_b32 s3, s12, 1
    v_mov_b32 v5, s3
    s_lshl_b32 s12, s12, 12
    s_lshl_b32 s3, s15, 11
    s_add_u32 s12, s12, s3
    v_lshl_add_u32 v2, v1, 4, s12
    s_mul_i32 s12, s14, 16640
    s_add_u32 s12, s12, s3
    s_add_u32 m0, s12, 32
    s_barrier
    global_load_lds_dwordx4 v2, s[42:43]
    global_load_lds_dwordx4 v2, s[42:43] offset:1024
    global_load_ushort v5, v5, s[44:45]
    s_sub_u32 s72, s6, 5
    s_cmp_gt_u32 s72, 1
    s_cbranch_scc1 L_B1
    s_lshl_b32 s72, s72, 17
    s_add_u32 s72, s72, s66
    v_lshrrev_b32 v4, 3, v1
    v_lshlrev_b32 v4, 14, v4
    v_lshl_add_u32 v4, v3, 7, v4
    v_add_u32 v4, s72, v4
    global_load_dword v4, v4, s[50:51] sc1
    s_branch L_B1
L_A1:
    s_mov_b32 s60, s46
    s_mov_b32 s61, s47
    s_mov_b32 s62, 4718592
    s_mov_b32 s63, 0x20000
    s_mov_b32 s67, 0xffff0000
    s_mov_b32 s68, 0x05040100
    s_mov_b32 s69, 0x07060302
    v_and_b32 v6, 15, v1
    v_lshrrev_b32 v7, 4, v1
    v_lshl_add_u32 v44, v7, 3, v6
    v_lshlrev_b32 v60, 4, v1
    v_add_u32 v60, 114688, v60
    s_cmp_lg_u32 s15, 0
    s_cbranch_scc1 L_A_nobox
    v_subrev_u32 v2, 6, v44
    v_med3_i32 v2, v2, 0, 31
    s_mov_b32 s3, 28672
    v_lshrrev_b32 v2, v2, s3
    v_bfe_u32 v16, v2, 0, 1
    v_bfe_u32 v3, v2, 1, 1
    v_lshl_or_b32 v16, v3, 16, v16
    v_mul_u32_u24 v16, 16256, v16
    v_bfe_u32 v17, v2, 2, 1
    v_bfe_u32 v3, v2, 3, 1
    v_lshl_or_b32 v17, v3, 16, v17
    v_mul_u32_u24 v17, 16256, v17
    v_bfe_u32 v18, v2, 4, 1
    v_bfe_u32 v3, v2, 5, 1
    v_lshl_or_b32 v18, v3, 16, v18
    v_mul_u32_u24 v18, 16256, v18
    v_bfe_u32 v19, v2, 6, 1
    v_bfe_u32 v3, v2, 7, 1
    v_lshl_or_b32 v19, v3, 16, v19
    v_mul_u32_u24 v19, 16256, v19
    v_subrev_u32_e64 v2, 9, v44
    v_med3_i32 v2, v2, 0, 31
    s_mov_b32 s3, 126976
    v_lshrrev_b32 v2, v2, s3
    v_bfe_u32 v20, v2, 0, 1
    v_bfe_u32 v3, v2, 1, 1
    v_lshl_or_b32 v20, v3, 16, v20
    v_mul_u32_u24 v20, 16256, v20
    v_bfe_u32 v21, v2, 2, 1
    v_bfe_u32 v3, v2, 3, 1
    v_lshl_or_b32 v21, v3, 16, v21
    v_mul_u32_u24 v21, 16256, v21
    v_bfe_u32 v22, v2, 4, 1
    v_bfe_u32 v3, v2, 5, 1
    v_lshl_or_b32 v22, v3, 16, v22
    v_mul_u32_u24 v22, 16256, v22
    v_bfe_u32 v23, v2, 6, 1
    v_bfe_u32 v3, v2, 7, 1
    v_lshl_or_b32 v23, v3, 16, v23
    v_mul_u32_u24 v23, 16256, v23
    v_subrev_u32_e64 v2, 14, v44
    v_med3_i32 v2, v2, 0, 31
    s_mov_b32 s3, 28672
    v_lshrrev_b32 v2, v2, s3
    v_bfe_u32 v24, v2, 0, 1
    v_bfe_u32 v3, v2, 1, 1
    v_lshl_or_b32 v24, v3, 16, v24
    v_mul_u32_u24 v24, 16256, v24
    v_bfe_u32 v25, v2, 2, 1
    v_bfe_u32 v3, v2, 3, 1
    v_lshl_or_b32 v25, v3, 16, v25
    v_mul_u32_u24 v25, 16256, v25
    v_bfe_u32 v26, v2, 4, 1
    v_bfe_u32 v3, v2, 5, 1
    v_lshl_or_b32 v26, v3, 16, v26
    v_mul_u32_u24 v26, 16256, v26
    v_bfe_u32 v27, v2, 6, 1
    v_bfe_u32 v3, v2, 7, 1
    v_lshl_or_b32 v27, v3, 16, v27
    v_mul_u32_u24 v27, 16256, v27
    v_subrev_u32_e64 v2, 9, v44
    v_med3_i32 v2, v2, 0, 31
    s_mov_b32 s3, 126976
    v_lshrrev_b32 v2, v2, s3
    v_bfe_u32 v28, v2, 0, 1
    v_bfe_u32 v3, v2, 1, 1
    v_lshl_or_b32 v28, v3, 16, v28
    v_mul_u32_u24 v28, 16256, v28
    v_bfe_u32 v29, v2, 2, 1
    v_bfe_u32 v3, v2, 3, 1
    v_lshl_or_b32 v29, v3, 16, v29
    v_mul_u32_u24 v29, 16256, v29
    v_bfe_u32 v30, v2, 4, 1
    v_bfe_u32 v3, v2, 5, 1
    v_lshl_or_b32 v30, v3, 16, v30
    v_mul_u32_u24 v30, 16256, v30
    v_bfe_u32 v31, v2, 6, 1
    v_bfe_u32 v3, v2, 7, 1
    v_lshl_or_b32 v31, v3, 16, v31
    v_mul_u32_u24 v31, 16256, v31
    v_subrev_u32_e64 v2, 8, v44
    v_med3_i32 v2, v2, 0, 31
    s_mov_b32 s3, 520192
    v_lshrrev_b32 v2, v2, s3
    v_bfe_u32 v32, v2, 0, 1
    v_bfe_u32 v3, v2, 1, 1
    v_lshl_or_b32 v32, v3, 16, v32
    v_mul_u32_u24 v32, 16256, v32
    v_bfe_u32 v33, v2, 2, 1
    v_bfe_u32 v3, v2, 3, 1
    v_lshl_or_b32 v33, v3, 16, v33
    v_mul_u32_u24 v33, 16256, v33
    v_bfe_u32 v34, v2, 4, 1
    v_bfe_u32 v3, v2, 5, 1
    v_lshl_or_b32 v34, v3, 16, v34
    v_mul_u32_u24 v34, 16256, v34
    v_bfe_u32 v35, v2, 6, 1
    v_bfe_u32 v3, v2, 7, 1
    v_lshl_or_b32 v35, v3, 16, v35
    v_mul_u32_u24 v35, 16256, v35
    v_subrev_u32_e64 v2, 7, v44
    v_med3_i32 v2, v2, 0, 31
    s_mov_b32 s3, 2093056
    v_lshrrev_b32 v2, v2, s3
    v_bfe_u32 v36, v2, 0, 1
    v_bfe_u32 v3, v2, 1, 1
    v_lshl_or_b32 v36, v3, 16, v36
    v_mul_u32_u24 v36, 16256, v36
    v_bfe_u32 v37, v2, 2, 1
    v_bfe_u32 v3, v2, 3, 1
    v_lshl_or_b32 v37, v3, 16, v37
    v_mul_u32_u24 v37, 16256, v37
    v_bfe_u32 v38, v2, 4, 1
    v_bfe_u32 v3, v2, 5, 1
    v_lshl_or_b32 v38, v3, 16, v38
    v_mul_u32_u24 v38, 16256, v38
    v_bfe_u32 v39, v2, 6, 1
    v_bfe_u32 v3, v2, 7, 1
    v_lshl_or_b32 v39, v3, 16, v39
    v_mul_u32_u24 v39, 16256, v39
    v_subrev_u32_e64 v2, 6, v44
    v_med3_i32 v2, v2, 0, 31
    s_mov_b32 s3, 12288
    v_lshrrev_b32 v2, v2, s3
    v_bfe_u32 v40, v2, 0, 1
    v_bfe_u32 v3, v2, 1, 1
    v_lshl_or_b32 v40, v3, 16, v40
    v_bfe_u32 v41, v2, 2, 1
    v_bfe_u32 v3, v2, 3, 1
    v_lshl_or_b32 v41, v3, 16, v41
    v_bfe_u32 v42, v2, 4, 1
    v_bfe_u32 v3, v2, 5, 1
    v_lshl_or_b32 v42, v3, 16, v42
    v_bfe_u32 v43, v2, 6, 1
    v_bfe_u32 v3, v2, 7, 1
    v_lshl_or_b32 v43, v3, 16, v43
    s_cmp_lg_u32 s6, 3
    s_cbranch_scc1 L_A_nobox
    ds_write_b128 v60, v[16:19] offset:0
    ds_write_b128 v60, v[20:23] offset:1024
    ds_write_b128 v60, v[24:27] offset:2048
    ds_write_b128 v60, v[28:31] offset:3072
    ds_write_b128 v60, v[32:35] offset:4096
    ds_write_b128 v60, v[36:39] offset:5120
    ds_write_b128 v60, v[40:43] offset:6144
    s_waitcnt lgkmcnt(0)
    v_mov_b32 v2, 121876
    v_mov_b32 v3, 1
    ds_write_b32 v2, v3
L_A_nobox:
    s_mul_i32 s11, s6, 8704
    s_mov_b32 m0, s11
    s_mul_i32 s13, s9, 12
    s_movk_i32 s3, 288
    s_cmp_eq_u32 s15, 0
    s_cselect_b32 s3, 544, s3
    v_mul_u32_u24 v53, s3, v6
    v_lshl_add_u32 v53, v7, 4, v53
    v_add_u32 v53, s11, v53
    s_mul_i32 s12, s8, 4608
    s_add_u32 s12, s12, 69696
    v_lshlrev_b32 v44, 1, v6
    v_sub_u32 v44, v44, v7
    v_lshlrev_b32 v44, 4, v44
    s_add_u32 s3, s12, 64
    v_add_u32_e64 v44, s3, v44
    v_lshl_add_u32 v2, v1, 3, s12
    ds_write_b64 v2, v[64:65]
    v_xor_b32 v54, 1, v0
    v_lshlrev_b32 v54, 3, v54
    v_add_u32 v54, 70208, v54
    v_mul_u32_u24 v5, 4608, v0
    v_add_u32_e64 v5, s13, v5
    v_mul_u32_u24 v45, 80, v6
    v_lshl_add_u32 v45, v7, 4, v45
    v_add_u32 v45, s11, v45
    s_mul_i32 s3, s6, 160
    v_and_b32 v2, 1, v7
    v_mul_u32_u24 v46, 80, v2
    v_lshl_add_u32 v46, v6, 2, v46
    v_add_u32 v46, s3, v46
    v_lshrrev_b32 v2, 5, v1
    v_mul_u32_u24 v3, 8704, v2
    v_add_u32 v47, v46, v3
    v_mul_u32_u24 v3, 1280, v2
    v_add_u32 v46, v46, v3
    s_lshl_b32 s3, s6, 5
    v_and_b32 v3, 31, v1
    v_lshl_add_u32 v2, v2, 8, v3
    v_add_u32 v2, s3, v2
    v_mul_u32_u24 v48, 2304, v2
    v_add_u32 v48, s13, v48
    s_mov_b32 s76, 0
    s_mov_b32 s77, 1179648
    v_min_u32 v2, 14, v1
    v_lshlrev_b32 v55, 4, v2
    v_cmp_le_u32 vcc, 2, v2
    v_mov_b32 v3, 1024
    s_nop 0
    v_cndmask_b32 v3, 0, v3, vcc
    v_add_u32 v55, v55, v3
    v_cmp_le_u32 vcc, 7, v2
    v_mov_b32 v3, 5328
    s_nop 0
    v_cndmask_b32 v3, 0, v3, vcc
    v_add_u32 v55, v55, v3
    v_cmp_le_u32 vcc, 11, v2
    v_mov_b32 v3, 256
    s_nop 0
    v_cndmask_b32 v3, 0, v3, vcc
    v_add_u32 v55, v55, v3
    v_add_u32 v55, s11, v55
    v_lshl_add_u32 v57, v6, 4, s11
    v_lshl_add_u32 v56, v7, 3, v57
    v_lshl_add_u32 v59, v1, 2, s11
    v_lshl_add_u32 v61, v1, 4, s11
    v_lshrrev_b32 v2, 1, v6
    v_lshl_add_u32 v2, v2, 2, s11
    v_and_b32 v3, 1, v6
    v_mul_u32_u24 v51, 516, v3
    v_add_u32_e64 v51, v51, v2
    v_add_u32 v51, 5500, v51
    v_mul_u32_u24 v52, 316, v3
    v_sub_u32 v52, v2, v52
    v_add_u32 v52, 6844, v52
    v_add_u32 v2, 1, v6
    v_and_b32 v3, 3, v2
    v_mul_u32_u24 v58, 1344, v3
    v_lshrrev_b32 v2, 2, v2
    v_lshl_add_u32 v58, v2, 3, v58
    v_lshl_add_u32 v58, v7, 4, v58
    v_add_u32 v58, s11, v58
    v_lshlrev_b32 v2, 2, v7
    v_sub_u32_e64 v2, v6, v2
    s_add_u32 s3, s11, 5496
    v_lshl_add_u32 v49, v2, 2, s3
    v_add_u32 v50, 1024, v49
    s_cmp_lg_u32 s15, 0
    s_cbranch_scc1 L_A_H
    s_setprio 0
    s_waitcnt vmcnt(0)
    s_mov_b32 s3, 0x3fb8aa3b
    v_lshlrev_b32 v96, 16, v14
    v_mul_f32 v96, s3, v96
    v_exp_f32 v96, v96
    v_lshlrev_b32 v84, 16, v8
    v_and_b32 v85, s67, v8
    v_lshlrev_b32 v86, 16, v9
    v_and_b32 v87, s67, v9
    v_lshlrev_b32 v88, 16, v10
    v_and_b32 v89, s67, v10
    v_lshlrev_b32 v90, 16, v11
    v_and_b32 v91, s67, v11
    v_lshlrev_b32 v92, 16, v12
    v_and_b32 v93, s67, v12
    v_lshlrev_b32 v94, 16, v13
    v_and_b32 v95, s67, v13
    v_cvt_pk_bf16_f32 v96, v96, v96
    v_and_b32 v96, s67, v96
    v_mul_f32 v98, s3, v96
    v_mul_f32 v99, 0.15915494, v96
    v_mul_f32 v84, v84, v98
    v_mul_f32 v86, v86, v99
    v_mul_f32 v85, v85, v98
    v_mul_f32 v87, v87, v99
    v_lshlrev_b32_e64 v15, 16, v15
    v_mul_f32 v140, 0x41000000, v84
    v_mul_f32 v142, 0x41000000, v86
    v_mul_f32 v141, 0x41000000, v85
    v_mul_f32 v143, 0x41000000, v87
    v_exp_f32 v140, v140
    v_fract_f32 v142, v142
    v_exp_f32 v141, v141
    v_fract_f32 v143, v143
    v_cos_f32 v112, v142
    v_sin_f32 v114, v142
    v_cos_f32 v113, v143
    v_sin_f32 v115, v143
    v_pk_mul_f32 v[112:113], v[112:113], v[140:141]
    v_pk_mul_f32 v[114:115], v[114:115], v[140:141]
    v_mov_b32 v128, 1.0
    v_mov_b32 v129, 1.0
    v_mov_b32 v130, 0
    v_mov_b32 v131, 0
    v_pk_mul_f32 v[140:141], v[114:115], v[114:115]
    v_cvt_pk_bf16_f32 v6, v128, v129
    v_pk_mul_f32 v[142:143], v[114:115], v[112:113]
    v_cvt_pk_bf16_f32 v7, v130, v131
    v_pk_fma_f32 v[122:123], v[112:113], v[114:115], v[142:143]
    ds_write_addtid_b32 v6 offset:0
    v_pk_fma_f32 v[120:121], v[112:113], v[112:113], v[140:141] neg_lo:[0,0,1] neg_hi:[0,0,1]
    ds_write_addtid_b32 v7 offset:256
    v_cvt_pk_bf16_f32 v62, v112, v113
    v_cvt_pk_bf16_f32 v63, v114, v115
    ds_write_addtid_b32 v62 offset:544
    ds_write_addtid_b32 v63 offset:800
    v_cvt_pk_bf16_f32 v6, v120, v121
    v_pk_mul_f32 v[144:145], v[114:115], v[122:123]
    v_cvt_pk_bf16_f32 v7, v122, v123
    v_pk_mul_f32 v[146:147], v[114:115], v[120:121]
    ds_write_addtid_b32 v6 offset:1088
    v_pk_fma_f32 v[134:135], v[112:113], v[122:123], v[146:147]
    ds_write_addtid_b32 v7 offset:1344
    v_pk_fma_f32 v[132:133], v[112:113], v[120:121], v[144:145] neg_lo:[0,0,1] neg_hi:[0,0,1]
    v_pk_mul_f32 v[140:141], v[122:123], v[122:123]
    v_cvt_pk_bf16_f32 v62, v132, v133
    v_pk_mul_f32 v[142:143], v[122:123], v[120:121]
    v_cvt_pk_bf16_f32 v63, v134, v135
    v_pk_fma_f32 v[130:131], v[120:121], v[122:123], v[142:143]
    ds_write_addtid_b32 v62 offset:1632
    v_pk_fma_f32 v[128:129], v[120:121], v[120:121], v[140:141] neg_lo:[0,0,1] neg_hi:[0,0,1]
    ds_write_addtid_b32 v63 offset:1888
    v_cvt_pk_bf16_f32 v6, v128, v129
    v_pk_mul_f32 v[144:145], v[134:135], v[122:123]
    v_cvt_pk_bf16_f32 v7, v130, v131
    v_pk_mul_f32 v[146:147], v[134:135], v[120:121]
    ds_write_addtid_b32 v6 offset:2176
    v_pk_fma_f32 v[134:135], v[132:133], v[122:123], v[146:147]
    ds_write_addtid_b32 v7 offset:2432
    v_pk_fma_f32 v[132:133], v[132:133], v[120:121], v[144:145] neg_lo:[0,0,1] neg_hi:[0,0,1]
    v_pk_mul_f32 v[140:141], v[130:131], v[122:123]
    v_cvt_pk_bf16_f32 v62, v132, v133
    v_pk_mul_f32 v[142:143], v[130:131], v[120:121]
    v_cvt_pk_bf16_f32 v63, v134, v135
    v_pk_fma_f32 v[130:131], v[128:129], v[122:123], v[142:143]
    ds_write_addtid_b32 v62 offset:2720
    v_pk_fma_f32 v[128:129], v[128:129], v[120:121], v[140:141] neg_lo:[0,0,1] neg_hi:[0,0,1]
    ds_write_addtid_b32 v63 offset:2976
    v_cvt_pk_bf16_f32 v6, v128, v129
    v_pk_mul_f32 v[144:145], v[134:135], v[122:123]
    v_cvt_pk_bf16_f32 v7, v130, v131
    v_pk_mul_f32 v[146:147], v[134:135], v[120:121]
    ds_write_addtid_b32 v6 offset:3264
    v_pk_fma_f32 v[134:135], v[132:133], v[122:123], v[146:147]
    ds_write_addtid_b32 v7 offset:3520
    v_pk_fma_f32 v[132:133], v[132:133], v[120:121], v[144:145] neg_lo:[0,0,1] neg_hi:[0,0,1]
    v_pk_mul_f32 v[140:141], v[130:131], v[122:123]
    v_cvt_pk_bf16_f32 v62, v132, v133
    v_pk_mul_f32 v[142:143], v[130:131], v[120:121]
    v_cvt_pk_bf16_f32 v63, v134, v135
    v_pk_fma_f32 v[130:131], v[128:129], v[122:123], v[142:143]
    ds_write_addtid_b32 v62 offset:3808
    v_pk_fma_f32 v[128:129], v[128:129], v[120:121], v[140:141] neg_lo:[0,0,1] neg_hi:[0,0,1]
    ds_write_addtid_b32 v63 offset:4064
    v_cvt_pk_bf16_f32 v6, v128, v129
    v_pk_mul_f32 v[144:145], v[134:135], v[122:123]
    v_cvt_pk_bf16_f32 v7, v130, v131
    v_pk_mul_f32 v[146:147], v[134:135], v[120:121]
    ds_write_addtid_b32 v6 offset:4352
    v_pk_fma_f32 v[134:135], v[132:133], v[122:123], v[146:147]
    ds_write_addtid_b32 v7 offset:4608
    v_pk_fma_f32 v[132:133], v[132:133], v[120:121], v[144:145] neg_lo:[0,0,1] neg_hi:[0,0,1]
    v_pk_mul_f32 v[140:141], v[130:131], v[122:123]
    v_cvt_pk_bf16_f32 v62, v132, v133
    v_pk_mul_f32 v[142:143], v[130:131], v[120:121]
    v_cvt_pk_bf16_f32 v63, v134, v135
    v_pk_fma_f32 v[130:131], v[128:129], v[122:123], v[142:143]
    ds_write_addtid_b32 v62 offset:4896
    v_pk_fma_f32 v[128:129], v[128:129], v[120:121], v[140:141] neg_lo:[0,0,1] neg_hi:[0,0,1]
    ds_write_addtid_b32 v63 offset:5152
    v_cvt_pk_bf16_f32 v6, v128, v129
    v_pk_mul_f32 v[144:145], v[134:135], v[122:123]
    v_cvt_pk_bf16_f32 v7, v130, v131
    v_pk_mul_f32 v[146:147], v[134:135], v[120:121]
    ds_write_addtid_b32 v6 offset:5440
    v_pk_fma_f32 v[134:135], v[132:133], v[122:123], v[146:147]
    ds_write_addtid_b32 v7 offset:5696
    v_pk_fma_f32 v[132:133], v[132:133], v[120:121], v[144:145] neg_lo:[0,0,1] neg_hi:[0,0,1]
    v_pk_mul_f32 v[140:141], v[130:131], v[122:123]
    v_cvt_pk_bf16_f32 v62, v132, v133
    v_pk_mul_f32 v[142:143], v[130:131], v[120:121]
    v_cvt_pk_bf16_f32 v63, v134, v135
    v_pk_fma_f32 v[130:131], v[128:129], v[122:123], v[142:143]
    ds_write_addtid_b32 v62 offset:5984
    v_pk_fma_f32 v[128:129], v[128:129], v[120:121], v[140:141] neg_lo:[0,0,1] neg_hi:[0,0,1]
    ds_write_addtid_b32 v63 offset:6240
    v_cvt_pk_bf16_f32 v6, v128, v129
    v_pk_mul_f32 v[144:145], v[134:135], v[122:123]
    v_cvt_pk_bf16_f32 v7, v130, v131
    v_pk_mul_f32 v[146:147], v[134:135], v[120:121]
    ds_write_addtid_b32 v6 offset:6528
    v_pk_fma_f32 v[134:135], v[132:133], v[122:123], v[146:147]
    ds_write_addtid_b32 v7 offset:6784
    v_pk_fma_f32 v[132:133], v[132:133], v[120:121], v[144:145] neg_lo:[0,0,1] neg_hi:[0,0,1]
    v_pk_mul_f32 v[140:141], v[130:131], v[122:123]
    v_cvt_pk_bf16_f32 v62, v132, v133
    v_pk_mul_f32 v[142:143], v[130:131], v[120:121]
    v_cvt_pk_bf16_f32 v63, v134, v135
    v_pk_fma_f32 v[130:131], v[128:129], v[122:123], v[142:143]
    ds_write_addtid_b32 v62 offset:7072
    v_pk_fma_f32 v[128:129], v[128:129], v[120:121], v[140:141] neg_lo:[0,0,1] neg_hi:[0,0,1]
    ds_write_addtid_b32 v63 offset:7328
    v_cvt_pk_bf16_f32 v6, v128, v129
    v_pk_mul_f32 v[144:145], v[134:135], v[122:123]
    v_cvt_pk_bf16_f32 v7, v130, v131
    v_pk_mul_f32 v[146:147], v[134:135], v[120:121]
    ds_write_addtid_b32 v6 offset:7616
    v_pk_fma_f32 v[134:135], v[132:133], v[122:123], v[146:147]
    ds_write_addtid_b32 v7 offset:7872
    v_pk_fma_f32 v[132:133], v[132:133], v[120:121], v[144:145] neg_lo:[0,0,1] neg_hi:[0,0,1]
    v_cvt_pk_bf16_f32 v62, v132, v133
    v_cvt_pk_bf16_f32 v63, v134, v135
    ds_write_addtid_b32 v62 offset:8160
    ds_write_addtid_b32 v63 offset:8416
    v_pk_mul_f32 v[140:141], v[130:131], v[122:123]
    v_pk_mul_f32 v[144:145], v[134:135], v[122:123]
    v_pk_mul_f32 v[142:143], v[130:131], v[120:121]
    v_pk_mul_f32 v[146:147], v[134:135], v[120:121]
    v_pk_fma_f32 v[130:131], v[128:129], v[122:123], v[142:143]
    v_pk_fma_f32 v[134:135], v[132:133], v[122:123], v[146:147]
    v_pk_fma_f32 v[128:129], v[128:129], v[120:121], v[140:141] neg_lo:[0,0,1] neg_hi:[0,0,1]
    v_pk_fma_f32 v[132:133], v[132:133], v[120:121], v[144:145] neg_lo:[0,0,1] neg_hi:[0,0,1]
    ds_read_b128 v[148:151], v53 offset:0
    ds_read_b128 v[152:155], v53 offset:64
    ds_read_b128 v[156:159], v53 offset:128
    ds_read_b128 v[160:163], v53 offset:192
    ds_read_b128 v[164:167], v53 offset:256
    ds_read_b128 v[168:171], v53 offset:320
    ds_read_b128 v[172:175], v53 offset:384
    ds_read_b128 v[176:179], v53 offset:448
    global_load_dwordx3 v[68:70], v5, s[16:17] offset:0
    v_cvt_pk_bf16_f32 v6, v128, v129
    v_cvt_pk_bf16_f32 v62, v132, v133
    v_cvt_pk_bf16_f32 v7, v130, v131
    v_cvt_pk_bf16_f32 v63, v134, v135
    ds_write_addtid_b32 v6 offset:0
    ds_write_addtid_b32 v62 offset:544
    ds_write_addtid_b32 v7 offset:256
    ds_write_addtid_b32 v63 offset:800
    v_pk_mul_f32 v[140:141], v[130:131], v[122:123]
    v_pk_mul_f32 v[144:145], v[134:135], v[122:123]
    v_pk_mul_f32 v[142:143], v[130:131], v[120:121]
    v_pk_mul_f32 v[146:147], v[134:135], v[120:121]
    v_pk_fma_f32 v[130:131], v[128:129], v[122:123], v[142:143]
    v_pk_fma_f32 v[134:135], v[132:133], v[122:123], v[146:147]
    v_pk_fma_f32 v[128:129], v[128:129], v[120:121], v[140:141] neg_lo:[0,0,1] neg_hi:[0,0,1]
    v_pk_fma_f32 v[132:133], v[132:133], v[120:121], v[144:145] neg_lo:[0,0,1] neg_hi:[0,0,1]
    v_cvt_pk_bf16_f32 v6, v128, v129
    v_cvt_pk_bf16_f32 v62, v132, v133
    v_cvt_pk_bf16_f32 v7, v130, v131
    v_cvt_pk_bf16_f32 v63, v134, v135
    ds_write_addtid_b32 v6 offset:1088
    ds_write_addtid_b32 v62 offset:1632
    ds_write_addtid_b32 v7 offset:1344
    ds_write_addtid_b32 v63 offset:1888
    v_pk_mul_f32 v[140:141], v[130:131], v[122:123]
    v_pk_mul_f32 v[144:145], v[134:135], v[122:123]
    v_pk_mul_f32 v[142:143], v[130:131], v[120:121]
    v_pk_mul_f32 v[146:147], v[134:135], v[120:121]
    v_pk_fma_f32 v[130:131], v[128:129], v[122:123], v[142:143]
    v_pk_fma_f32 v[134:135], v[132:133], v[122:123], v[146:147]
    v_pk_fma_f32 v[128:129], v[128:129], v[120:121], v[140:141] neg_lo:[0,0,1] neg_hi:[0,0,1]
    v_pk_fma_f32 v[132:133], v[132:133], v[120:121], v[144:145] neg_lo:[0,0,1] neg_hi:[0,0,1]
    v_cvt_pk_bf16_f32 v6, v128, v129
    v_cvt_pk_bf16_f32 v62, v132, v133
    v_cvt_pk_bf16_f32 v7, v130, v131
    v_cvt_pk_bf16_f32 v63, v134, v135
    ds_write_addtid_b32 v6 offset:2176
    ds_write_addtid_b32 v62 offset:2720
    ds_write_addtid_b32 v7 offset:2432
    ds_write_addtid_b32 v63 offset:2976
    v_pk_mul_f32 v[140:141], v[130:131], v[122:123]
    v_pk_mul_f32 v[144:145], v[134:135], v[122:123]
    v_pk_mul_f32 v[142:143], v[130:131], v[120:121]
    v_pk_mul_f32 v[146:147], v[134:135], v[120:121]
    v_pk_fma_f32 v[130:131], v[128:129], v[122:123], v[142:143]
    v_pk_fma_f32 v[134:135], v[132:133], v[122:123], v[146:147]
    v_pk_fma_f32 v[128:129], v[128:129], v[120:121], v[140:141] neg_lo:[0,0,1] neg_hi:[0,0,1]
    v_pk_fma_f32 v[132:133], v[132:133], v[120:121], v[144:145] neg_lo:[0,0,1] neg_hi:[0,0,1]
    v_cvt_pk_bf16_f32 v6, v128, v129
    v_cvt_pk_bf16_f32 v62, v132, v133
    v_cvt_pk_bf16_f32 v7, v130, v131
    v_cvt_pk_bf16_f32 v63, v134, v135
    ds_write_addtid_b32 v6 offset:3264
    ds_write_addtid_b32 v62 offset:3808
    ds_write_addtid_b32 v7 offset:3520
    ds_write_addtid_b32 v63 offset:4064
    global_load_dwordx3 v[72:74], v5, s[16:17] offset:1152
    v_pk_mul_f32 v[140:141], v[130:131], v[122:123]
    v_pk_mul_f32 v[144:145], v[134:135], v[122:123]
    v_pk_mul_f32 v[142:143], v[130:131], v[120:121]
    v_pk_mul_f32 v[146:147], v[134:135], v[120:121]
    v_pk_fma_f32 v[130:131], v[128:129], v[122:123], v[142:143]
    v_pk_fma_f32 v[134:135], v[132:133], v[122:123], v[146:147]
    v_pk_fma_f32 v[128:129], v[128:129], v[120:121], v[140:141] neg_lo:[0,0,1] neg_hi:[0,0,1]
    v_pk_fma_f32 v[132:133], v[132:133], v[120:121], v[144:145] neg_lo:[0,0,1] neg_hi:[0,0,1]
    v_cvt_pk_bf16_f32 v6, v128, v129
    v_cvt_pk_bf16_f32 v62, v132, v133
    v_cvt_pk_bf16_f32 v7, v130, v131
    v_cvt_pk_bf16_f32 v63, v134, v135
    ds_write_addtid_b32 v6 offset:4352
    ds_write_addtid_b32 v62 offset:4896
    ds_write_addtid_b32 v7 offset:4608
    ds_write_addtid_b32 v63 offset:5152
    v_pk_mul_f32 v[140:141], v[130:131], v[122:123]
    v_pk_mul_f32 v[144:145], v[134:135], v[122:123]
    v_pk_mul_f32 v[142:143], v[130:131], v[120:121]
    v_pk_mul_f32 v[146:147], v[134:135], v[120:121]
    v_pk_fma_f32 v[130:131], v[128:129], v[122:123], v[142:143]
    v_pk_fma_f32 v[134:135], v[132:133], v[122:123], v[146:147]
    v_pk_fma_f32 v[128:129], v[128:129], v[120:121], v[140:141] neg_lo:[0,0,1] neg_hi:[0,0,1]
    v_pk_fma_f32 v[132:133], v[132:133], v[120:121], v[144:145] neg_lo:[0,0,1] neg_hi:[0,0,1]
    v_cvt_pk_bf16_f32 v6, v128, v129
    v_cvt_pk_bf16_f32 v62, v132, v133
    v_cvt_pk_bf16_f32 v7, v130, v131
    v_cvt_pk_bf16_f32 v63, v134, v135
    ds_write_addtid_b32 v6 offset:5440
    ds_write_addtid_b32 v62 offset:5984
    ds_write_addtid_b32 v7 offset:5696
    ds_write_addtid_b32 v63 offset:6240
    v_pk_mul_f32 v[140:141], v[130:131], v[122:123]
    v_pk_mul_f32 v[144:145], v[134:135], v[122:123]
    v_pk_mul_f32 v[142:143], v[130:131], v[120:121]
    v_pk_mul_f32 v[146:147], v[134:135], v[120:121]
    v_pk_fma_f32 v[130:131], v[128:129], v[122:123], v[142:143]
    v_pk_fma_f32 v[134:135], v[132:133], v[122:123], v[146:147]
    v_pk_fma_f32 v[128:129], v[128:129], v[120:121], v[140:141] neg_lo:[0,0,1] neg_hi:[0,0,1]
    v_pk_fma_f32 v[132:133], v[132:133], v[120:121], v[144:145] neg_lo:[0,0,1] neg_hi:[0,0,1]
    v_cvt_pk_bf16_f32 v6, v128, v129
    v_cvt_pk_bf16_f32 v62, v132, v133
    v_cvt_pk_bf16_f32 v7, v130, v131
    v_cvt_pk_bf16_f32 v63, v134, v135
    ds_write_addtid_b32 v6 offset:6528
    ds_write_addtid_b32 v62 offset:7072
    ds_write_addtid_b32 v7 offset:6784
    ds_write_addtid_b32 v63 offset:7328
    v_pk_mul_f32 v[140:141], v[130:131], v[122:123]
    v_pk_mul_f32 v[144:145], v[134:135], v[122:123]
    v_pk_mul_f32 v[142:143], v[130:131], v[120:121]
    v_pk_mul_f32 v[146:147], v[134:135], v[120:121]
    v_pk_fma_f32 v[130:131], v[128:129], v[122:123], v[142:143]
    v_pk_fma_f32 v[134:135], v[132:133], v[122:123], v[146:147]
    v_pk_fma_f32 v[128:129], v[128:129], v[120:121], v[140:141] neg_lo:[0,0,1] neg_hi:[0,0,1]
    v_pk_fma_f32 v[132:133], v[132:133], v[120:121], v[144:145] neg_lo:[0,0,1] neg_hi:[0,0,1]
    v_cvt_pk_bf16_f32 v6, v128, v129
    v_cvt_pk_bf16_f32 v62, v132, v133
    v_cvt_pk_bf16_f32 v7, v130, v131
    v_cvt_pk_bf16_f32 v63, v134, v135
    ds_write_addtid_b32 v6 offset:7616
    ds_write_addtid_b32 v62 offset:8160
    ds_write_addtid_b32 v7 offset:7872
    ds_write_addtid_b32 v63 offset:8416
    v_exp_f32 v140, v84
    v_fract_f32 v142, v86
    v_exp_f32 v141, v85
    v_fract_f32 v143, v87
    v_cos_f32 v100, v142
    v_sin_f32 v102, v142
    v_cos_f32 v101, v143
    v_sin_f32 v103, v143
    v_pk_mul_f32 v[100:101], v[100:101], v[140:141]
    v_pk_mul_f32 v[102:103], v[102:103], v[140:141]
    ds_read_b128 v[180:183], v53 offset:0
    ds_read_b128 v[184:187], v53 offset:64
    ds_read_b128 v[188:191], v53 offset:128
    ds_read_b128 v[192:195], v53 offset:192
    ds_read_b128 v[196:199], v53 offset:256
    ds_read_b128 v[200:203], v53 offset:320
    ds_read_b128 v[204:207], v53 offset:384
    ds_read_b128 v[208:211], v53 offset:448
    global_load_dwordx3 v[76:78], v5, s[16:17] offset:2304
    v_mul_f32 v140, 0x43800000, v84
    v_mul_f32 v142, 0x43800000, v86
    v_mul_f32 v141, 0x43800000, v85
    v_mul_f32 v143, 0x43800000, v87
    v_exp_f32 v140, v140
    v_fract_f32 v142, v142
    v_exp_f32 v141, v141
    v_fract_f32 v143, v143
    v_cos_f32 v116, v142
    v_sin_f32 v118, v142
    v_cos_f32 v117, v143
    v_sin_f32 v119, v143
    v_pk_mul_f32 v[116:117], v[116:117], v[140:141]
    v_pk_mul_f32 v[118:119], v[118:119], v[140:141]
    v_pk_mul_f32 v[140:141], v[94:95], v[90:91]
    v_pk_mul_f32 v[144:145], v[102:103], v[102:103]
    v_pk_mul_f32 v[142:143], v[94:95], v[88:89]
    v_pk_mul_f32 v[146:147], v[102:103], v[100:101]
    v_pk_fma_f32 v[126:127], v[92:93], v[90:91], v[142:143]
    v_pk_fma_f32 v[106:107], v[100:101], v[102:103], v[146:147]
    v_pk_fma_f32 v[124:125], v[92:93], v[88:89], v[140:141] neg_lo:[0,0,1] neg_hi:[0,0,1]
    v_pk_fma_f32 v[104:105], v[100:101], v[100:101], v[144:145] neg_lo:[0,0,1] neg_hi:[0,0,1]
    v_pk_mul_f32 v[124:125], v[124:125], v[96:97] op_sel_hi:[1,0]
    v_pk_mul_f32 v[126:127], v[126:127], v[96:97] op_sel_hi:[1,0]
    v_pk_mul_f32 v[140:141], v[106:107], v[106:107]
    v_pk_mul_f32 v[144:145], v[126:127], v[118:119]
    v_pk_mul_f32 v[142:143], v[106:107], v[104:105]
    v_pk_mul_f32 v[146:147], v[126:127], v[116:117]
    v_pk_fma_f32 v[110:111], v[104:105], v[106:107], v[142:143]
    v_pk_fma_f32 v[134:135], v[124:125], v[118:119], v[146:147]
    v_pk_fma_f32 v[108:109], v[104:105], v[104:105], v[140:141] neg_lo:[0,0,1] neg_hi:[0,0,1]
    v_pk_fma_f32 v[132:133], v[124:125], v[116:117], v[144:145] neg_lo:[0,0,1] neg_hi:[0,0,1]
    v_cvt_pk_bf16_f32 v6, v124, v125
    v_cvt_pk_bf16_f32 v62, v132, v133
    v_cvt_pk_bf16_f32 v7, -v126, -v127
    v_cvt_pk_bf16_f32 v63, -v134, -v135
    ds_write_addtid_b32 v6 offset:0
    ds_write_addtid_b32 v62 offset:4352
    ds_write_addtid_b32 v7 offset:256
    ds_write_addtid_b32 v63 offset:4608
    v_pk_mul_f32 v[140:141], v[126:127], v[102:103]
    v_pk_mul_f32 v[144:145], v[134:135], v[106:107]
    v_pk_mul_f32 v[142:143], v[126:127], v[100:101]
    v_pk_mul_f32 v[146:147], v[134:135], v[104:105]
    v_pk_fma_f32 v[130:131], v[124:125], v[102:103], v[142:143]
    v_pk_fma_f32 v[138:139], v[132:133], v[106:107], v[146:147]
    v_pk_fma_f32 v[128:129], v[124:125], v[100:101], v[140:141] neg_lo:[0,0,1] neg_hi:[0,0,1]
    v_pk_fma_f32 v[136:137], v[132:133], v[104:105], v[144:145] neg_lo:[0,0,1] neg_hi:[0,0,1]
    v_cvt_pk_bf16_f32 v6, v128, v129
    v_cvt_pk_bf16_f32 v62, v136, v137
    v_cvt_pk_bf16_f32 v7, -v130, -v131
    v_cvt_pk_bf16_f32 v63, -v138, -v139
    ds_write_addtid_b32 v6 offset:544
    ds_write_addtid_b32 v62 offset:4896
    ds_write_addtid_b32 v7 offset:800
    ds_write_addtid_b32 v63 offset:5152
    v_pk_mul_f32 v[140:141], v[130:131], v[102:103]
    v_pk_mul_f32 v[144:145], v[138:139], v[106:107]
    v_pk_mul_f32 v[142:143], v[130:131], v[100:101]
    v_pk_mul_f32 v[146:147], v[138:139], v[104:105]
    v_pk_fma_f32 v[130:131], v[128:129], v[102:103], v[142:143]
    v_pk_fma_f32 v[138:139], v[136:137], v[106:107], v[146:147]
    v_pk_fma_f32 v[128:129], v[128:129], v[100:101], v[140:141] neg_lo:[0,0,1] neg_hi:[0,0,1]
    v_pk_fma_f32 v[136:137], v[136:137], v[104:105], v[144:145] neg_lo:[0,0,1] neg_hi:[0,0,1]
    v_cvt_pk_bf16_f32 v6, v128, v129
    v_cvt_pk_bf16_f32 v62, v136, v137
    v_cvt_pk_bf16_f32 v7, -v130, -v131
    v_cvt_pk_bf16_f32 v63, -v138, -v139
    ds_write_addtid_b32 v6 offset:1088
    ds_write_addtid_b32 v62 offset:5440
    ds_write_addtid_b32 v7 offset:1344
    ds_write_addtid_b32 v63 offset:5696
    v_pk_mul_f32 v[140:141], v[130:131], v[102:103]
    v_pk_mul_f32 v[144:145], v[138:139], v[106:107]
    v_pk_mul_f32 v[142:143], v[130:131], v[100:101]
    v_pk_mul_f32 v[146:147], v[138:139], v[104:105]
    v_pk_fma_f32 v[130:131], v[128:129], v[102:103], v[142:143]
    v_pk_fma_f32 v[138:139], v[136:137], v[106:107], v[146:147]
    v_pk_fma_f32 v[128:129], v[128:129], v[100:101], v[140:141] neg_lo:[0,0,1] neg_hi:[0,0,1]
    v_pk_fma_f32 v[136:137], v[136:137], v[104:105], v[144:145] neg_lo:[0,0,1] neg_hi:[0,0,1]
    v_cvt_pk_bf16_f32 v6, v128, v129
    v_cvt_pk_bf16_f32 v62, v136, v137
    v_cvt_pk_bf16_f32 v7, -v130, -v131
    v_cvt_pk_bf16_f32 v63, -v138, -v139
    ds_write_addtid_b32 v6 offset:1632
    ds_write_addtid_b32 v62 offset:5984
    ds_write_addtid_b32 v7 offset:1888
    ds_write_addtid_b32 v63 offset:6240
    global_load_dwordx3 v[80:82], v5, s[16:17] offset:3456
    v_pk_mul_f32 v[140:141], v[130:131], v[102:103]
    v_pk_mul_f32 v[144:145], v[134:135], v[118:119]
    v_pk_mul_f32 v[142:143], v[130:131], v[100:101]
    v_pk_mul_f32 v[146:147], v[134:135], v[116:117]
    v_pk_fma_f32 v[130:131], v[128:129], v[102:103], v[142:143]
    v_pk_fma_f32 v[134:135], v[132:133], v[118:119], v[146:147]
    v_pk_fma_f32 v[128:129], v[128:129], v[100:101], v[140:141] neg_lo:[0,0,1] neg_hi:[0,0,1]
    v_pk_fma_f32 v[132:133], v[132:133], v[116:117], v[144:145] neg_lo:[0,0,1] neg_hi:[0,0,1]
    v_cvt_pk_bf16_f32 v6, v128, v129
    v_cvt_pk_bf16_f32 v62, v132, v133
    v_cvt_pk_bf16_f32 v7, -v130, -v131
    v_cvt_pk_bf16_f32 v63, -v134, -v135
    ds_write_addtid_b32 v6 offset:2176
    ds_write_addtid_b32 v62 offset:6528
    ds_write_addtid_b32 v7 offset:2432
    ds_write_addtid_b32 v63 offset:6784
    v_pk_mul_f32 v[140:141], v[130:131], v[102:103]
    v_pk_mul_f32 v[144:145], v[134:135], v[110:111]
    v_pk_mul_f32 v[142:143], v[130:131], v[100:101]
    v_pk_mul_f32 v[146:147], v[134:135], v[108:109]
    v_pk_fma_f32 v[130:131], v[128:129], v[102:103], v[142:143]
    v_pk_fma_f32 v[138:139], v[132:133], v[110:111], v[146:147]
    v_pk_fma_f32 v[128:129], v[128:129], v[100:101], v[140:141] neg_lo:[0,0,1] neg_hi:[0,0,1]
    v_pk_fma_f32 v[136:137], v[132:133], v[108:109], v[144:145] neg_lo:[0,0,1] neg_hi:[0,0,1]
    v_cvt_pk_bf16_f32 v6, v128, v129
    v_cvt_pk_bf16_f32 v62, v136, v137
    v_cvt_pk_bf16_f32 v7, -v130, -v131
    v_cvt_pk_bf16_f32 v63, -v138, -v139
    ds_write_addtid_b32 v6 offset:2720
    ds_write_addtid_b32 v62 offset:7072
    ds_write_addtid_b32 v7 offset:2976
    ds_write_addtid_b32 v63 offset:7328
    v_pk_mul_f32 v[140:141], v[130:131], v[102:103]
    v_pk_mul_f32 v[144:145], v[134:135], v[118:119]
    v_pk_mul_f32 v[142:143], v[130:131], v[100:101]
    v_pk_mul_f32 v[146:147], v[134:135], v[116:117]
    v_pk_fma_f32 v[130:131], v[128:129], v[102:103], v[142:143]
    v_pk_fma_f32 v[134:135], v[132:133], v[118:119], v[146:147]
    v_pk_fma_f32 v[128:129], v[128:129], v[100:101], v[140:141] neg_lo:[0,0,1] neg_hi:[0,0,1]
    v_pk_fma_f32 v[132:133], v[132:133], v[116:117], v[144:145] neg_lo:[0,0,1] neg_hi:[0,0,1]
    v_cvt_pk_bf16_f32 v6, v128, v129
    v_cvt_pk_bf16_f32 v62, v132, v133
    v_cvt_pk_bf16_f32 v7, -v130, -v131
    v_cvt_pk_bf16_f32 v63, -v134, -v135
    ds_write_addtid_b32 v6 offset:3264
    ds_write_addtid_b32 v62 offset:7616
    ds_write_addtid_b32 v7 offset:3520
    ds_write_addtid_b32 v63 offset:7872
    v_pk_mul_f32 v[140:141], v[130:131], v[102:103]
    v_pk_mul_f32 v[144:145], v[134:135], v[110:111]
    v_pk_mul_f32 v[142:143], v[130:131], v[100:101]
    v_pk_mul_f32 v[146:147], v[134:135], v[108:109]
    v_pk_fma_f32 v[130:131], v[128:129], v[102:103], v[142:143]
    v_pk_fma_f32 v[138:139], v[132:133], v[110:111], v[146:147]
    v_pk_fma_f32 v[128:129], v[128:129], v[100:101], v[140:141] neg_lo:[0,0,1] neg_hi:[0,0,1]
    v_pk_fma_f32 v[136:137], v[132:133], v[108:109], v[144:145] neg_lo:[0,0,1] neg_hi:[0,0,1]
    v_cvt_pk_bf16_f32 v6, v128, v129
    v_cvt_pk_bf16_f32 v62, v136, v137
    v_cvt_pk_bf16_f32 v7, -v130, -v131
    v_cvt_pk_bf16_f32 v63, -v138, -v139
    ds_write_addtid_b32 v6 offset:3808
    ds_write_addtid_b32 v62 offset:8160
    ds_write_addtid_b32 v7 offset:4064
    ds_write_addtid_b32 v63 offset:8416
    v_pk_mul_f32 v[140:141], v[118:119], v[118:119]
    v_pk_mul_f32 v[144:145], v[134:135], v[118:119]
    v_pk_mul_f32 v[142:143], v[118:119], v[116:117]
    v_pk_mul_f32 v[146:147], v[134:135], v[116:117]
    v_pk_fma_f32 v[122:123], v[116:117], v[118:119], v[142:143]
    v_pk_fma_f32 v[130:131], v[132:133], v[118:119], v[146:147]
    v_pk_fma_f32 v[120:121], v[116:117], v[116:117], v[140:141] neg_lo:[0,0,1] neg_hi:[0,0,1]
    v_pk_fma_f32 v[128:129], v[132:133], v[116:117], v[144:145] neg_lo:[0,0,1] neg_hi:[0,0,1]
    ds_read_b128 v[212:215], v53 offset:0
    ds_read_b128 v[216:219], v53 offset:64
    ds_read_b128 v[220:223], v53 offset:128
    ds_read_b128 v[224:227], v53 offset:192
    ds_read_b128 v[228:231], v53 offset:256
    ds_read_b128 v[232:235], v53 offset:320
    ds_read_b128 v[236:239], v53 offset:384
    ds_read_b128 v[240:243], v53 offset:448
    v_cvt_pk_bf16_f32 v6, v128, v129
    v_pk_mul_f32 v[144:145], v[130:131], v[118:119]
    v_cvt_pk_bf16_f32 v7, -v130, -v131
    v_pk_mul_f32 v[146:147], v[130:131], v[116:117]
    ds_write_addtid_b32 v6 offset:0
    v_pk_fma_f32 v[134:135], v[128:129], v[118:119], v[146:147]
    ds_write_addtid_b32 v7 offset:256
    v_pk_fma_f32 v[132:133], v[128:129], v[116:117], v[144:145] neg_lo:[0,0,1] neg_hi:[0,0,1]
    v_pk_mul_f32 v[140:141], v[130:131], v[122:123]
    v_cvt_pk_bf16_f32 v62, v132, v133
    v_pk_mul_f32 v[142:143], v[130:131], v[120:121]
    v_cvt_pk_bf16_f32 v63, -v134, -v135
    v_pk_fma_f32 v[138:139], v[128:129], v[122:123], v[142:143]
    ds_write_addtid_b32 v62 offset:544
    v_pk_fma_f32 v[136:137], v[128:129], v[120:121], v[140:141] neg_lo:[0,0,1] neg_hi:[0,0,1]
    ds_write_addtid_b32 v63 offset:800
    v_cvt_pk_bf16_f32 v6, v136, v137
    v_pk_mul_f32 v[144:145], v[134:135], v[122:123]
    v_cvt_pk_bf16_f32 v7, -v138, -v139
    v_pk_mul_f32 v[146:147], v[134:135], v[120:121]
    ds_write_addtid_b32 v6 offset:1088
    v_pk_fma_f32 v[134:135], v[132:133], v[122:123], v[146:147]
    ds_write_addtid_b32 v7 offset:1344
    v_pk_fma_f32 v[132:133], v[132:133], v[120:121], v[144:145] neg_lo:[0,0,1] neg_hi:[0,0,1]
    v_pk_mul_f32 v[140:141], v[138:139], v[122:123]
    v_cvt_pk_bf16_f32 v62, v132, v133
    v_pk_mul_f32 v[142:143], v[138:139], v[120:121]
    v_cvt_pk_bf16_f32 v63, -v134, -v135
    v_pk_fma_f32 v[138:139], v[136:137], v[122:123], v[142:143]
    ds_write_addtid_b32 v62 offset:1632
    v_pk_fma_f32 v[136:137], v[136:137], v[120:121], v[140:141] neg_lo:[0,0,1] neg_hi:[0,0,1]
    ds_write_addtid_b32 v63 offset:1888
    v_cvt_pk_bf16_f32 v6, v136, v137
    v_cvt_pk_bf16_f32 v7, -v138, -v139
    ds_write_addtid_b32 v6 offset:2176
    ds_write_addtid_b32 v7 offset:2432
    ds_read_b128 v[84:87], v53 offset:0
    ds_read_b128 v[88:91], v53 offset:64
    ds_read_b128 v[92:95], v53 offset:128
    ds_read_b128 v[96:99], v53 offset:192
    ds_read_b128 v[100:103], v53 offset:256
    ds_read_b128 v[104:107], v53 offset:320
    ds_read_b128 v[108:111], v53 offset:384
    ds_read_b128 v[112:115], v53 offset:448
    ds_write_b128 v61, v[64:67] offset:5440
    ds_write_b128 v55, v[64:67]
    s_waitcnt lgkmcnt(15)
    v_mfma_f32_16x16x32_bf16 v[116:119], v[212:215], v[148:151], 0
    v_mfma_f32_16x16x32_bf16 v[120:123], v[212:215], v[180:183], 0
    v_mfma_f32_16x16x32_bf16 v[116:119], v[216:219], v[152:155], v[116:119]
    v_mfma_f32_16x16x32_bf16 v[120:123], v[216:219], v[184:187], v[120:123]
    v_mfma_f32_16x16x32_bf16 v[116:119], v[220:223], v[156:159], v[116:119]
    v_mfma_f32_16x16x32_bf16 v[120:123], v[220:223], v[188:191], v[120:123]
    v_mfma_f32_16x16x32_bf16 v[116:119], v[224:227], v[160:163], v[116:119]
    v_mfma_f32_16x16x32_bf16 v[120:123], v[224:227], v[192:195], v[120:123]
    v_mfma_f32_16x16x32_bf16 v[116:119], v[228:231], v[164:167], v[116:119]
    v_mfma_f32_16x16x32_bf16 v[120:123], v[228:231], v[196:199], v[120:123]
    v_mfma_f32_16x16x32_bf16 v[116:119], v[232:235], v[168:171], v[116:119]
    v_mfma_f32_16x16x32_bf16 v[120:123], v[232:235], v[200:203], v[120:123]
    v_mfma_f32_16x16x32_bf16 v[116:119], v[236:239], v[172:175], v[116:119]
    v_mfma_f32_16x16x32_bf16 v[120:123], v[236:239], v[204:207], v[120:123]
    v_mfma_f32_16x16x32_bf16 v[116:119], v[240:243], v[176:179], v[116:119]
    v_mfma_f32_16x16x32_bf16 v[120:123], v[240:243], v[208:211], v[120:123]
    s_waitcnt lgkmcnt(9)
    v_mfma_f32_16x16x32_bf16 v[124:127], v[84:87], v[148:151], 0
    v_mfma_f32_16x16x32_bf16 v[128:131], v[84:87], v[180:183], 0
    s_waitcnt lgkmcnt(8)
    v_mfma_f32_16x16x32_bf16 v[124:127], v[88:91], v[152:155], v[124:127]
    v_mfma_f32_16x16x32_bf16 v[128:131], v[88:91], v[184:187], v[128:131]
    s_waitcnt lgkmcnt(7)
    v_mfma_f32_16x16x32_bf16 v[124:127], v[92:95], v[156:159], v[124:127]
    v_mfma_f32_16x16x32_bf16 v[128:131], v[92:95], v[188:191], v[128:131]
    s_waitcnt lgkmcnt(6)
    v_mfma_f32_16x16x32_bf16 v[124:127], v[96:99], v[160:163], v[124:127]
    v_mfma_f32_16x16x32_bf16 v[128:131], v[96:99], v[192:195], v[128:131]
    s_mov_b64 exec, 1
    v_add_f32_e64 v116, v116, v15
    s_mov_b64 exec, -1
    s_waitcnt lgkmcnt(5)
    v_mfma_f32_16x16x32_bf16 v[124:127], v[100:103], v[164:167], v[124:127]
    v_mfma_f32_16x16x32_bf16 v[128:131], v[100:103], v[196:199], v[128:131]
    v_cvt_pk_bf16_f32 v132, v116, v117
    v_cvt_pk_bf16_f32 v133, v118, v119
    v_cvt_pk_bf16_f32 v140, v116, v116
    v_cvt_pk_bf16_f32 v141, v117, v118
    v_cvt_pk_bf16_f32 v142, v118, v118
    s_waitcnt lgkmcnt(4)
    v_mfma_f32_16x16x32_bf16 v[124:127], v[104:107], v[168:171], v[124:127]
    v_mfma_f32_16x16x32_bf16 v[128:131], v[104:107], v[200:203], v[128:131]
    v_cvt_pk_bf16_f32 v134, v120, v121
    v_cvt_pk_bf16_f32 v135, v122, v123
    v_cvt_pk_bf16_f32 v144, v120, v120
    v_cvt_pk_bf16_f32 v145, v121, v122
    v_cvt_pk_bf16_f32 v146, v122, v122
    s_waitcnt lgkmcnt(3)
    v_mfma_f32_16x16x32_bf16 v[124:127], v[108:111], v[172:175], v[124:127]
    v_mfma_f32_16x16x32_bf16 v[128:131], v[108:111], v[204:207], v[128:131]
    v_mov_b32_dpp v6, v120 row_ror:15 row_mask:0xf bank_mask:0xf
    v_mov_b32_dpp v7, v116 wave_shl:1 row_mask:0xf bank_mask:0xf
    s_nop 0
    v_mov_b32_dpp v6, v116 row_shl:1 row_mask:0xf bank_mask:0xf
    v_mov_b32_dpp v7, v120 row_shl:1 row_mask:0xf bank_mask:0xf
    v_cvt_pk_bf16_f32 v143, v119, v6
    s_waitcnt lgkmcnt(2)
    v_mfma_f32_16x16x32_bf16 v[124:127], v[112:115], v[176:179], v[124:127]
    v_mfma_f32_16x16x32_bf16 v[128:131], v[112:115], v[208:211], v[128:131]
    v_cvt_pk_bf16_f32 v147, v123, v7
    v_cvt_pk_bf16_f32 v7, v116, 0
    v_mov_b32 v6, v140
    s_branch L_A_tab
L_A_H:
    s_setprio 0
    v_and_b32 v2, 1, v1
    v_lshlrev_b32 v2, 4, v2
    s_lshl_b32 s3, s14, 12
    s_add_u32 s3, s3, 98304
    v_lshl_add_u32 v94, v1, 4, s3
    s_waitcnt vmcnt(1)
    s_mov_b32 s3, 0x3fb8aa3b
    v_lshlrev_b32 v90, 16, v14
    v_mul_f32 v90, s3, v90
    v_exp_f32 v90, v90
    v_lshrrev_b32 v84, v2, v8
    v_lshlrev_b32 v84, 16, v84
    v_lshrrev_b32 v85, v2, v9
    v_lshlrev_b32 v85, 16, v85
    v_lshrrev_b32 v86, v2, v10
    v_lshlrev_b32 v86, 16, v86
    v_lshrrev_b32 v87, v2, v11
    v_lshlrev_b32 v87, 16, v87
    v_lshrrev_b32 v88, v2, v12
    v_lshlrev_b32 v88, 16, v88
    v_lshrrev_b32 v89, v2, v13
    v_lshlrev_b32 v89, 16, v89
    v_cvt_pk_bf16_f32 v90, v90, v90
    v_and_b32 v90, s67, v90
    v_mul_f32 v92, s3, v90
    v_mul_f32 v93, 0.15915494, v90
    v_mul_f32 v84, v84, v92
    v_mul_f32 v85, v85, v93
    v_lshlrev_b32 v15, 16, v15
    v_mul_f32 v168, 0x41000000, v84
    v_mul_f32 v169, 0x41000000, v85
    v_exp_f32 v168, v168
    v_fract_f32 v169, v169
    v_cos_f32 v154, v169
    v_sin_f32 v155, v169
    v_mul_f32 v154, v154, v168
    v_mul_f32 v155, v155, v168
    v_mov_b32 v162, 1.0
    v_mov_b32 v163, 0
    v_mul_f32 v168, v155, v155
    v_cvt_pk_bf16_f32 v172, v162, v163
    v_mul_f32 v169, v155, v154
    ds_write_addtid_b32 v172 offset:0
    v_fma_f32 v159, v154, v155, v169
    v_cvt_pk_bf16_f32 v173, v154, v155
    v_fma_f32 v158, v154, v154, -v168
    ds_write_addtid_b32 v173 offset:288
    v_cvt_pk_bf16_f32 v172, v158, v159
    v_mul_f32 v170, v155, v159
    ds_write_addtid_b32 v172 offset:576
    v_mul_f32 v171, v155, v158
    v_mul_f32 v168, v159, v159
    v_fma_f32 v165, v154, v159, v171
    v_mul_f32 v169, v159, v158
    v_fma_f32 v164, v154, v158, -v170
    v_fma_f32 v163, v158, v159, v169
    v_cvt_pk_bf16_f32 v173, v164, v165
    v_fma_f32 v162, v158, v158, -v168
    ds_write_addtid_b32 v173 offset:864
    v_cvt_pk_bf16_f32 v172, v162, v163
    v_mul_f32 v170, v165, v159
    ds_write_addtid_b32 v172 offset:1152
    v_mul_f32 v171, v165, v158
    v_mul_f32 v168, v163, v159
    v_fma_f32 v165, v164, v159, v171
    v_mul_f32 v169, v163, v158
    v_fma_f32 v164, v164, v158, -v170
    v_fma_f32 v163, v162, v159, v169
    v_cvt_pk_bf16_f32 v173, v164, v165
    v_fma_f32 v162, v162, v158, -v168
    ds_write_addtid_b32 v173 offset:1440
    v_cvt_pk_bf16_f32 v172, v162, v163
    v_mul_f32 v170, v165, v159
    ds_write_addtid_b32 v172 offset:1728
    v_mul_f32 v171, v165, v158
    v_mul_f32 v168, v163, v159
    v_fma_f32 v165, v164, v159, v171
    v_mul_f32 v169, v163, v158
    v_fma_f32 v164, v164, v158, -v170
    v_fma_f32 v163, v162, v159, v169
    v_cvt_pk_bf16_f32 v173, v164, v165
    v_fma_f32 v162, v162, v158, -v168
    ds_write_addtid_b32 v173 offset:2016
    v_cvt_pk_bf16_f32 v172, v162, v163
    v_mul_f32 v170, v165, v159
    ds_write_addtid_b32 v172 offset:2304
    v_mul_f32 v171, v165, v158
    v_mul_f32 v168, v163, v159
    v_fma_f32 v165, v164, v159, v171
    v_mul_f32 v169, v163, v158
    v_fma_f32 v164, v164, v158, -v170
    v_fma_f32 v163, v162, v159, v169
    v_cvt_pk_bf16_f32 v173, v164, v165
    v_fma_f32 v162, v162, v158, -v168
    ds_write_addtid_b32 v173 offset:2592
    v_cvt_pk_bf16_f32 v172, v162, v163
    v_mul_f32 v170, v165, v159
    ds_write_addtid_b32 v172 offset:2880
    v_mul_f32 v171, v165, v158
    v_mul_f32 v168, v163, v159
    v_fma_f32 v165, v164, v159, v171
    v_mul_f32 v169, v163, v158
    v_fma_f32 v164, v164, v158, -v170
    v_fma_f32 v163, v162, v159, v169
    v_cvt_pk_bf16_f32 v173, v164, v165
    v_fma_f32 v162, v162, v158, -v168
    ds_write_addtid_b32 v173 offset:3168
    v_cvt_pk_bf16_f32 v172, v162, v163
    v_mul_f32 v170, v165, v159
    ds_write_addtid_b32 v172 offset:3456
    v_mul_f32 v171, v165, v158
    v_mul_f32 v168, v163, v159
    v_fma_f32 v165, v164, v159, v171
    v_mul_f32 v169, v163, v158
    v_fma_f32 v164, v164, v158, -v170
    v_fma_f32 v163, v162, v159, v169
    v_cvt_pk_bf16_f32 v173, v164, v165
    v_fma_f32 v162, v162, v158, -v168
    ds_write_addtid_b32 v173 offset:3744
    v_cvt_pk_bf16_f32 v172, v162, v163
    v_mul_f32 v170, v165, v159
    ds_write_addtid_b32 v172 offset:4032
    v_mul_f32 v171, v165, v158
    v_fma_f32 v165, v164, v159, v171
    v_fma_f32 v164, v164, v158, -v170
    v_cvt_pk_bf16_f32 v173, v164, v165
    ds_write_addtid_b32 v173 offset:4320
    v_mul_f32 v168, v163, v159
    v_mul_f32 v170, v165, v159
    v_mul_f32 v169, v163, v158
    v_mul_f32 v171, v165, v158
    v_fma_f32 v163, v162, v159, v169
    v_fma_f32 v165, v164, v159, v171
    v_fma_f32 v162, v162, v158, -v168
    v_fma_f32 v164, v164, v158, -v170
    ds_read_b128 v[176:179], v53 offset:0
    ds_read_b128 v[180:183], v53 offset:64
    ds_read_b128 v[184:187], v53 offset:128
    ds_read_b128 v[188:191], v53 offset:192
    global_load_dwordx3 v[68:70], v5, s[16:17] offset:0
    v_cvt_pk_bf16_f32 v172, v162, v163
    v_cvt_pk_bf16_f32 v173, v164, v165
    ds_write_addtid_b32 v172 offset:0
    ds_write_addtid_b32 v173 offset:288
    v_mul_f32 v168, v163, v159
    v_mul_f32 v170, v165, v159
    v_mul_f32 v169, v163, v158
    v_mul_f32 v171, v165, v158
    v_fma_f32 v163, v162, v159, v169
    v_fma_f32 v165, v164, v159, v171
    v_fma_f32 v162, v162, v158, -v168
    v_fma_f32 v164, v164, v158, -v170
    v_cvt_pk_bf16_f32 v172, v162, v163
    v_cvt_pk_bf16_f32 v173, v164, v165
    ds_write_addtid_b32 v172 offset:576
    ds_write_addtid_b32 v173 offset:864
    v_mul_f32 v168, v163, v159
    v_mul_f32 v170, v165, v159
    v_mul_f32 v169, v163, v158
    v_mul_f32 v171, v165, v158
    v_fma_f32 v163, v162, v159, v169
    v_fma_f32 v165, v164, v159, v171
    v_fma_f32 v162, v162, v158, -v168
    v_fma_f32 v164, v164, v158, -v170
    v_cvt_pk_bf16_f32 v172, v162, v163
    v_cvt_pk_bf16_f32 v173, v164, v165
    ds_write_addtid_b32 v172 offset:1152
    ds_write_addtid_b32 v173 offset:1440
    v_mul_f32 v168, v163, v159
    v_mul_f32 v170, v165, v159
    v_mul_f32 v169, v163, v158
    v_mul_f32 v171, v165, v158
    v_fma_f32 v163, v162, v159, v169
    v_fma_f32 v165, v164, v159, v171
    v_fma_f32 v162, v162, v158, -v168
    v_fma_f32 v164, v164, v158, -v170
    v_cvt_pk_bf16_f32 v172, v162, v163
    v_cvt_pk_bf16_f32 v173, v164, v165
    ds_write_addtid_b32 v172 offset:1728
    ds_write_addtid_b32 v173 offset:2016
    v_mul_f32 v168, v163, v159
    v_mul_f32 v170, v165, v159
    v_mul_f32 v169, v163, v158
    v_mul_f32 v171, v165, v158
    v_fma_f32 v163, v162, v159, v169
    v_fma_f32 v165, v164, v159, v171
    v_fma_f32 v162, v162, v158, -v168
    v_fma_f32 v164, v164, v158, -v170
    v_cvt_pk_bf16_f32 v172, v162, v163
    v_cvt_pk_bf16_f32 v173, v164, v165
    ds_write_addtid_b32 v172 offset:2304
    ds_write_addtid_b32 v173 offset:2592
    v_mul_f32 v168, v163, v159
    v_mul_f32 v170, v165, v159
    v_mul_f32 v169, v163, v158
    v_mul_f32 v171, v165, v158
    v_fma_f32 v163, v162, v159, v169
    v_fma_f32 v165, v164, v159, v171
    v_fma_f32 v162, v162, v158, -v168
    v_fma_f32 v164, v164, v158, -v170
    v_cvt_pk_bf16_f32 v172, v162, v163
    v_cvt_pk_bf16_f32 v173, v164, v165
    ds_write_addtid_b32 v172 offset:2880
    ds_write_addtid_b32 v173 offset:3168
    v_mul_f32 v168, v163, v159
    v_mul_f32 v170, v165, v159
    v_mul_f32 v169, v163, v158
    v_mul_f32 v171, v165, v158
    v_fma_f32 v163, v162, v159, v169
    v_fma_f32 v165, v164, v159, v171
    v_fma_f32 v162, v162, v158, -v168
    v_fma_f32 v164, v164, v158, -v170
    v_cvt_pk_bf16_f32 v172, v162, v163
    v_cvt_pk_bf16_f32 v173, v164, v165
    ds_write_addtid_b32 v172 offset:3456
    ds_write_addtid_b32 v173 offset:3744
    v_mul_f32 v168, v163, v159
    v_mul_f32 v170, v165, v159
    v_mul_f32 v169, v163, v158
    v_mul_f32 v171, v165, v158
    v_fma_f32 v163, v162, v159, v169
    v_fma_f32 v165, v164, v159, v171
    v_fma_f32 v162, v162, v158, -v168
    v_fma_f32 v164, v164, v158, -v170
    v_cvt_pk_bf16_f32 v172, v162, v163
    v_cvt_pk_bf16_f32 v173, v164, v165
    ds_write_addtid_b32 v172 offset:4032
    ds_write_addtid_b32 v173 offset:4320
    v_exp_f32 v168, v84
    v_fract_f32 v169, v85
    v_cos_f32 v148, v169
    v_sin_f32 v149, v169
    v_mul_f32 v148, v148, v168
    v_mul_f32 v149, v149, v168
    ds_read_b128 v[192:195], v53 offset:0
    ds_read_b128 v[196:199], v53 offset:64
    ds_read_b128 v[200:203], v53 offset:128
    ds_read_b128 v[204:207], v53 offset:192
    global_load_dwordx3 v[72:74], v5, s[16:17] offset:1152
    v_mul_f32 v168, 0x43800000, v84
    v_mul_f32 v169, 0x43800000, v85
    v_exp_f32 v168, v168
    v_fract_f32 v169, v169
    v_cos_f32 v156, v169
    v_sin_f32 v157, v169
    v_mul_f32 v156, v156, v168
    v_mul_f32 v157, v157, v168
    v_mul_f32 v168, v89, v87
    v_mul_f32 v170, v149, v149
    v_mul_f32 v169, v89, v86
    v_mul_f32 v171, v149, v148
    v_fma_f32 v161, v88, v87, v169
    v_fma_f32 v151, v148, v149, v171
    v_fma_f32 v160, v88, v86, -v168
    v_fma_f32 v150, v148, v148, -v170
    v_mul_f32 v160, v160, v90
    v_mul_f32 v161, v161, v90
    v_mul_f32 v168, v151, v151
    v_mul_f32 v170, v161, v157
    v_mul_f32 v169, v151, v150
    v_mul_f32 v171, v161, v156
    v_fma_f32 v153, v150, v151, v169
    v_fma_f32 v165, v160, v157, v171
    v_fma_f32 v152, v150, v150, -v168
    v_fma_f32 v164, v160, v156, -v170
    v_cvt_pk_bf16_f32 v172, v160, -v161
    v_cvt_pk_bf16_f32 v173, v164, -v165
    ds_write_addtid_b32 v172 offset:0
    ds_write_addtid_b32 v173 offset:2304
    v_mul_f32 v168, v161, v149
    v_mul_f32 v170, v165, v151
    v_mul_f32 v169, v161, v148
    v_mul_f32 v171, v165, v150
    v_fma_f32 v163, v160, v149, v169
    v_fma_f32 v167, v164, v151, v171
    v_fma_f32 v162, v160, v148, -v168
    v_fma_f32 v166, v164, v150, -v170
    v_cvt_pk_bf16_f32 v172, v162, -v163
    v_cvt_pk_bf16_f32 v173, v166, -v167
    ds_write_addtid_b32 v172 offset:288
    ds_write_addtid_b32 v173 offset:2592
    v_mul_f32 v168, v163, v149
    v_mul_f32 v170, v167, v151
    v_mul_f32 v169, v163, v148
    v_mul_f32 v171, v167, v150
    v_fma_f32 v163, v162, v149, v169
    v_fma_f32 v167, v166, v151, v171
    v_fma_f32 v162, v162, v148, -v168
    v_fma_f32 v166, v166, v150, -v170
    v_cvt_pk_bf16_f32 v172, v162, -v163
    v_cvt_pk_bf16_f32 v173, v166, -v167
    ds_write_addtid_b32 v172 offset:576
    ds_write_addtid_b32 v173 offset:2880
    v_mul_f32 v168, v163, v149
    v_mul_f32 v170, v167, v151
    v_mul_f32 v169, v163, v148
    v_mul_f32 v171, v167, v150
    v_fma_f32 v163, v162, v149, v169
    v_fma_f32 v167, v166, v151, v171
    v_fma_f32 v162, v162, v148, -v168
    v_fma_f32 v166, v166, v150, -v170
    v_cvt_pk_bf16_f32 v172, v162, -v163
    v_cvt_pk_bf16_f32 v173, v166, -v167
    ds_write_addtid_b32 v172 offset:864
    ds_write_addtid_b32 v173 offset:3168
    v_mul_f32 v168, v163, v149
    v_mul_f32 v170, v165, v157
    v_mul_f32 v169, v163, v148
    v_mul_f32 v171, v165, v156
    v_fma_f32 v163, v162, v149, v169
    v_fma_f32 v165, v164, v157, v171
    v_fma_f32 v162, v162, v148, -v168
    v_fma_f32 v164, v164, v156, -v170
    v_cvt_pk_bf16_f32 v172, v162, -v163
    v_cvt_pk_bf16_f32 v173, v164, -v165
    ds_write_addtid_b32 v172 offset:1152
    ds_write_addtid_b32 v173 offset:3456
    v_mul_f32 v168, v163, v149
    v_mul_f32 v170, v165, v153
    v_mul_f32 v169, v163, v148
    v_mul_f32 v171, v165, v152
    v_fma_f32 v163, v162, v149, v169
    v_fma_f32 v167, v164, v153, v171
    v_fma_f32 v162, v162, v148, -v168
    v_fma_f32 v166, v164, v152, -v170
    v_cvt_pk_bf16_f32 v172, v162, -v163
    v_cvt_pk_bf16_f32 v173, v166, -v167
    ds_write_addtid_b32 v172 offset:1440
    ds_write_addtid_b32 v173 offset:3744
    v_mul_f32 v168, v163, v149
    v_mul_f32 v170, v165, v157
    v_mul_f32 v169, v163, v148
    v_mul_f32 v171, v165, v156
    v_fma_f32 v163, v162, v149, v169
    v_fma_f32 v165, v164, v157, v171
    v_fma_f32 v162, v162, v148, -v168
    v_fma_f32 v164, v164, v156, -v170
    v_cvt_pk_bf16_f32 v172, v162, -v163
    v_cvt_pk_bf16_f32 v173, v164, -v165
    ds_write_addtid_b32 v172 offset:1728
    ds_write_addtid_b32 v173 offset:4032
    v_mul_f32 v168, v163, v149
    v_mul_f32 v170, v165, v153
    v_mul_f32 v169, v163, v148
    v_mul_f32 v171, v165, v152
    v_fma_f32 v163, v162, v149, v169
    v_fma_f32 v167, v164, v153, v171
    v_fma_f32 v162, v162, v148, -v168
    v_fma_f32 v166, v164, v152, -v170
    v_cvt_pk_bf16_f32 v172, v162, -v163
    v_cvt_pk_bf16_f32 v173, v166, -v167
    ds_write_addtid_b32 v172 offset:2016
    ds_write_addtid_b32 v173 offset:4320
    v_mul_f32 v168, v157, v157
    v_mul_f32 v170, v165, v157
    v_mul_f32 v169, v157, v156
    v_mul_f32 v171, v165, v156
    v_fma_f32 v159, v156, v157, v169
    v_fma_f32 v163, v164, v157, v171
    v_fma_f32 v158, v156, v156, -v168
    v_fma_f32 v162, v164, v156, -v170
    ds_read_b128 v[208:211], v53 offset:0
    ds_read_b128 v[212:215], v53 offset:64
    ds_read_b128 v[216:219], v53 offset:128
    ds_read_b128 v[220:223], v53 offset:192
    global_load_dwordx3 v[76:78], v5, s[16:17] offset:2304
    v_cvt_pk_bf16_f32 v172, v162, -v163
    v_mul_f32 v170, v163, v157
    ds_write_addtid_b32 v172 offset:0
    v_mul_f32 v171, v163, v156
    v_mul_f32 v168, v163, v159
    v_fma_f32 v165, v162, v157, v171
    v_mul_f32 v169, v163, v158
    v_fma_f32 v164, v162, v156, -v170
    v_fma_f32 v167, v162, v159, v169
    v_cvt_pk_bf16_f32 v173, v164, -v165
    v_fma_f32 v166, v162, v158, -v168
    ds_write_addtid_b32 v173 offset:288
    v_cvt_pk_bf16_f32 v172, v166, -v167
    v_mul_f32 v170, v165, v159
    ds_write_addtid_b32 v172 offset:576
    v_mul_f32 v171, v165, v158
    v_mul_f32 v168, v167, v159
    v_fma_f32 v165, v164, v159, v171
    v_mul_f32 v169, v167, v158
    v_fma_f32 v164, v164, v158, -v170
    v_fma_f32 v167, v166, v159, v169
    v_cvt_pk_bf16_f32 v173, v164, -v165
    v_fma_f32 v166, v166, v158, -v168
    ds_write_addtid_b32 v173 offset:864
    v_cvt_pk_bf16_f32 v172, v166, -v167
    ds_write_addtid_b32 v172 offset:1152
    ds_read_b128 v[224:227], v53 offset:0
    ds_read_b128 v[228:231], v53 offset:64
    ds_read_b128 v[232:235], v53 offset:128
    ds_read_b128 v[236:239], v53 offset:192
    global_load_dwordx3 v[80:82], v5, s[16:17] offset:3456
    ds_write_b128 v61, v[64:67] offset:5440
    ds_write_b128 v55, v[64:67]
    v_mov_b32 v96, 121876
    s_mov_b32 s75, 0
L_A_sp0:
    ds_read_b32 v97, v96 offset:0
    s_add_u32 s75, s75, 1
    s_waitcnt lgkmcnt(0)
    v_readfirstlane_b32 s3, v97
    s_nop 0
    s_cmp_eq_u32 s3, 1
    s_cbranch_scc1 L_A_sp0d
    s_sleep 1
    s_cmp_lt_u32 s75, 0x400000
    s_cbranch_scc1 L_A_sp0
L_A_sp0d:
    s_nop 0
    ds_read_b128 v[16:19], v60 offset:0
    ds_read_b128 v[20:23], v60 offset:1024
    ds_read_b128 v[24:27], v60 offset:2048
    ds_read_b128 v[28:31], v60 offset:3072
    ds_read_b128 v[32:35], v60 offset:4096
    ds_read_b128 v[36:39], v60 offset:5120
    ds_read_b128 v[40:43], v60 offset:6144
    s_setprio 1
    v_mfma_f32_16x16x32_bf16 v[116:119], v[208:211], v[176:179], 0
    v_mfma_f32_16x16x32_bf16 v[120:123], v[208:211], v[192:195], 0
    v_mfma_f32_16x16x32_bf16 v[116:119], v[212:215], v[180:183], v[116:119]
    v_mfma_f32_16x16x32_bf16 v[120:123], v[212:215], v[196:199], v[120:123]
    v_mfma_f32_16x16x32_bf16 v[116:119], v[216:219], v[184:187], v[116:119]
    v_mfma_f32_16x16x32_bf16 v[120:123], v[216:219], v[200:203], v[120:123]
    v_mfma_f32_16x16x32_bf16 v[116:119], v[220:223], v[188:191], v[116:119]
    v_mfma_f32_16x16x32_bf16 v[120:123], v[220:223], v[204:207], v[120:123]
    v_mfma_f32_16x16x32_bf16 v[124:127], v[224:227], v[176:179], 0
    v_mfma_f32_16x16x32_bf16 v[128:131], v[224:227], v[192:195], 0
    v_mfma_f32_16x16x32_bf16 v[124:127], v[228:231], v[180:183], v[124:127]
    v_mfma_f32_16x16x32_bf16 v[128:131], v[228:231], v[196:199], v[128:131]
    v_mfma_f32_16x16x32_bf16 v[124:127], v[232:235], v[184:187], v[124:127]
    v_mfma_f32_16x16x32_bf16 v[128:131], v[232:235], v[200:203], v[128:131]
    v_mfma_f32_16x16x32_bf16 v[124:127], v[236:239], v[188:191], v[124:127]
    v_mfma_f32_16x16x32_bf16 v[128:131], v[236:239], v[204:207], v[128:131]
    s_lshl_b32 s3, s14, 2
    s_add_u32 s3, s3, 121856
    v_mov_b32 v96, s3
    v_mov_b32 v97, 1
    ds_write_b128 v94, v[116:119] offset:0
    ds_write_b128 v94, v[120:123] offset:1024
    s_nop 0
    ds_write_b128 v94, v[124:127] offset:2048
    ds_write_b128 v94, v[128:131] offset:3072
    s_waitcnt lgkmcnt(0)
    ds_write_b32 v96, v97
    v_xor_b32 v96, 4, v96
    v_xor_b32 v94, 4096, v94
    s_mov_b32 s75, 0
L_A_sp1:
    ds_read_b32 v97, v96 offset:0
    s_add_u32 s75, s75, 1
    s_waitcnt lgkmcnt(0)
    v_readfirstlane_b32 s3, v97
    s_nop 0
    s_cmp_eq_u32 s3, 1
    s_cbranch_scc1 L_A_sp1d
    s_sleep 1
    s_cmp_lt_u32 s75, 0x400000
    s_cbranch_scc1 L_A_sp1
L_A_sp1d:
    ds_read_b128 v[240:243], v94 offset:0
    ds_read_b128 v[244:247], v94 offset:1024
    ds_read_b128 v[248:251], v94 offset:2048
    ds_read_b128 v[252:255], v94 offset:3072
    s_waitcnt lgkmcnt(3)
    v_add_f32 v116, v116, v240
    v_add_f32 v117, v117, v241
    v_add_f32 v118, v118, v242
    v_add_f32 v119, v119, v243
    s_waitcnt lgkmcnt(2)
    v_add_f32 v120, v120, v244
    v_add_f32 v121, v121, v245
    v_add_f32 v122, v122, v246
    v_add_f32 v123, v123, v247
    s_waitcnt lgkmcnt(1)
    v_add_f32 v124, v124, v248
    v_add_f32 v125, v125, v249
    v_add_f32 v126, v126, v250
    v_add_f32 v127, v127, v251
    s_waitcnt lgkmcnt(0)
    v_add_f32 v128, v128, v252
    v_add_f32 v129, v129, v253
    v_add_f32 v130, v130, v254
    v_add_f32 v131, v131, v255
    s_mov_b64 exec, 1
    v_add_f32_e64 v116, v116, v15
    s_mov_b64 exec, -1
    v_cvt_pk_bf16_f32 v132, v116, v117
    v_cvt_pk_bf16_f32 v133, v118, v119
    v_cvt_pk_bf16_f32 v140, v116, v116
    v_cvt_pk_bf16_f32 v141, v117, v118
    v_cvt_pk_bf16_f32 v142, v118, v118
    v_cvt_pk_bf16_f32 v134, v120, v121
    v_cvt_pk_bf16_f32 v135, v122, v123
    v_cvt_pk_bf16_f32 v144, v120, v120
    v_cvt_pk_bf16_f32 v145, v121, v122
    v_cvt_pk_bf16_f32 v146, v122, v122
    v_mov_b32_dpp v6, v120 row_ror:15 row_mask:0xf bank_mask:0xf
    v_mov_b32_dpp v7, v116 wave_shl:1 row_mask:0xf bank_mask:0xf
    s_nop 0
    s_nop 0
    v_mov_b32_dpp v6, v116 row_shl:1 row_mask:0xf bank_mask:0xf
    v_mov_b32_dpp v7, v120 row_shl:1 row_mask:0xf bank_mask:0xf
    v_cvt_pk_bf16_f32 v143, v119, v6
    v_cvt_pk_bf16_f32 v147, v123, v7
    v_cvt_pk_bf16_f32 v7, v116, 0
    v_mov_b32 v6, v140
L_A_tab:
    s_mov_b32 exec_lo, 0x0
    s_mov_b32 exec_hi, 0xffff
    ds_write_b128 v57, v[140:143] offset:544
    ds_write_b128 v57, v[144:147] offset:800
    s_mov_b32 exec_lo, 0xffffffff
    s_mov_b32 exec_hi, 0x0
    ds_write_b64 v56, v[132:133] offset:32
    ds_write_b64 v56, v[134:135] offset:288
    s_mov_b32 exec_lo, 0x0
    s_mov_b32 exec_hi, 0x10000
    ds_write_b64 v57, v[6:7] offset:1056
    v_and_b32_e64 v132, s67, v132
    s_mov_b64 exec, -1
    ds_read2_b32 v[84:85], v59 offset0:0 offset1:1
    ds_read2_b32 v[86:87], v59 offset0:64 offset1:65
    ds_read2_b32 v[88:89], v59 offset0:128 offset1:129
    ds_read2_b32 v[90:91], v59 offset0:192 offset1:193
    v_add_u32 v59, 1024, v59
    ds_read2_b32 v[92:93], v59 offset0:0 offset1:1
    v_cvt_pk_bf16_f32 v136, v124, v125
    v_cvt_pk_bf16_f32 v137, v126, v127
    v_cvt_pk_bf16_f32 v138, v128, v129
    v_cvt_pk_bf16_f32 v139, v130, v131
    s_waitcnt lgkmcnt(4)
    ds_write_addtid_b32 v84 offset:2684
    v_alignbit_b32 v85, v85, v84, 16
    ds_write_addtid_b32 v85 offset:1344
    ds_write_addtid_b32 v85 offset:4028
    s_waitcnt lgkmcnt(6)
    ds_write_addtid_b32 v86 offset:2940
    v_alignbit_b32 v87, v87, v86, 16
    ds_write_addtid_b32 v87 offset:1600
    ds_write_addtid_b32 v87 offset:4284
    s_waitcnt lgkmcnt(8)
    ds_write_addtid_b32 v88 offset:3196
    v_alignbit_b32 v89, v89, v88, 16
    ds_write_addtid_b32 v89 offset:1856
    ds_write_addtid_b32 v89 offset:4540
    s_waitcnt lgkmcnt(10)
    ds_write_addtid_b32 v90 offset:3452
    v_alignbit_b32 v91, v91, v90, 16
    ds_write_addtid_b32 v91 offset:2112
    ds_write_addtid_b32 v91 offset:4796
    s_waitcnt lgkmcnt(12)
    s_nop 0
    ds_write_addtid_b32 v92 offset:3708
    v_alignbit_b32 v93, v93, v92, 16
    ds_write_addtid_b32 v93 offset:2368
    ds_write_addtid_b32 v93 offset:5052
    v_readlane_b32 s3, v136, 0
    v_readlane_b32 s12, v136, 16
    v_readlane_b32 s72, v139, 14
    s_and_b32 s3, s3, 0xffff
    s_and_b32 s12, s12, 0xffff
    s_and_b32 s72, s72, s67
    s_or_b32 s12, s12, s72
    ds_read_b64 v[148:149], v58 offset:0
    ds_read_b64 v[150:151], v58 offset:8
    ds_read_b64 v[152:153], v58 offset:64
    ds_read_b64 v[154:155], v58 offset:72
    ds_read_b64 v[156:157], v58 offset:128
    ds_read_b64 v[158:159], v58 offset:136
    ds_read_b64 v[160:161], v58 offset:192
    ds_read_b64 v[162:163], v58 offset:200
    ds_read_b64 v[164:165], v58 offset:256
    ds_read_b64 v[166:167], v58 offset:264
    ds_read_b64 v[168:169], v58 offset:320
    ds_read_b64 v[170:171], v58 offset:328
    ds_read_b64 v[172:173], v58 offset:384
    ds_read_b64 v[174:175], v58 offset:392
    ds_read_b64 v[176:177], v58 offset:448
    ds_read_b64 v[178:179], v58 offset:456
    ds_read_b64 v[180:181], v58 offset:512
    ds_read_b64 v[182:183], v58 offset:520
    ds_read_b64 v[184:185], v58 offset:576
    ds_read_b64 v[186:187], v58 offset:584
    ds_read_b64 v[188:189], v58 offset:640
    ds_read_b64 v[190:191], v58 offset:648
    ds_read_b64 v[192:193], v58 offset:704
    ds_read_b64 v[194:195], v58 offset:712
    ds_read_b64 v[196:197], v58 offset:768
    ds_read_b64 v[198:199], v58 offset:776
    ds_read_b64 v[200:201], v58 offset:832
    ds_read_b64 v[202:203], v58 offset:840
    ds_read_b64 v[204:205], v58 offset:896
    ds_read_b64 v[206:207], v58 offset:904
    ds_read_b64 v[208:209], v58 offset:960
    ds_read_b64 v[210:211], v58 offset:968
    ds_read_b64 v[212:213], v58 offset:1024
    ds_read_b64 v[214:215], v58 offset:1032
    v_mul_u32_u24 v40, s3, v40
    v_mul_u32_u24 v41, s3, v41
    v_mul_u32_u24 v42, s3, v42
    v_mul_u32_u24 v43, s3, v43
    v_mov_b32 v102, 0
    v_mov_b32 v140, 0
    v_writelane_b32 v102, s3, 48
    v_mov_b32_dpp v141, v132 row_ror:2 row_mask:0xf bank_mask:0xf
    v_mov_b32_dpp v142, v134 row_ror:2 row_mask:0xf bank_mask:0xf
    v_mov_b32_dpp v143, v133 row_ror:2 row_mask:0xf bank_mask:0xf
    v_mov_b32_dpp v144, v135 row_ror:2 row_mask:0xf bank_mask:0xf
    v_mov_b32_dpp v140, v132 row_shr:2 row_mask:0xf bank_mask:0xf
    v_mov_b32_dpp v141, v134 row_shr:2 row_mask:0xf bank_mask:0xf
    v_mov_b32_dpp v142, v133 row_shr:2 row_mask:0xf bank_mask:0xf
    v_mov_b32_dpp v143, v135 row_shr:2 row_mask:0xf bank_mask:0xf
    v_mov_b32_dpp v144, v102 row_shr:2 row_mask:0xf bank_mask:0xf
    v_perm_b32 v84, v140, v132, s68
    v_perm_b32 v85, v140, v132, s69
    v_perm_b32 v86, v141, v134, s68
    v_perm_b32 v87, v141, v134, s69
    v_perm_b32 v88, v142, v133, s68
    v_perm_b32 v89, v142, v133, s69
    v_perm_b32 v90, v143, v135, s68
    v_perm_b32 v91, v143, v135, s69
    v_perm_b32 v92, v144, v102, s68
    v_perm_b32 v93, v144, v102, s69
    s_mov_b32 exec_lo, 0
    s_nop 0
    s_mov_b32 exec_hi, 0xffff0000
    ds_write2_b32 v51, v84, v85 offset0:0 offset1:64
    ds_write2_b32 v51, v86, v87 offset0:8 offset1:72
    ds_write2_b32 v51, v88, v89 offset0:16 offset1:80
    ds_write2_b32 v51, v90, v91 offset0:24 offset1:88
    ds_write2_b32 v51, v92, v93 offset0:32 offset1:96
    s_mov_b64 exec, 1
    v_and_b32 v136, s67, v136
    v_mov_b32 v102, s12
    ds_write_b32 v52, v102 offset:256
    s_mov_b64 exec, -1
    v_lshlrev_b32 v94, 16, v138
    v_alignbit_b32 v95, v139, v138, 16
    s_nop 0
    v_mov_b32_dpp v140, v94 row_ror:2 row_mask:0xf bank_mask:0xf
    v_mov_b32_dpp v141, v95 row_ror:2 row_mask:0xf bank_mask:0xf
    v_mov_b32_dpp v142, v136 row_ror:2 row_mask:0xf bank_mask:0xf
    v_mov_b32_dpp v143, v137 row_ror:2 row_mask:0xf bank_mask:0xf
    v_mov_b32_dpp v140, v136 row_shr:2 row_mask:0xf bank_mask:0xf
    v_mov_b32_dpp v141, v137 row_shr:2 row_mask:0xf bank_mask:0xf
    v_mov_b32_dpp v142, v138 row_shr:2 row_mask:0xf bank_mask:0xf
    v_mov_b32_dpp v143, v139 row_shr:2 row_mask:0xf bank_mask:0xf
    v_perm_b32 v94, v140, v136, s68
    v_perm_b32 v96, v140, v136, s69
    v_perm_b32 v98, v141, v137, s68
    v_perm_b32 v100, v141, v137, s69
    v_perm_b32 v95, v142, v138, s68
    v_perm_b32 v97, v142, v138, s69
    v_perm_b32 v99, v143, v139, s68
    v_perm_b32 v101, v143, v139, s69
    s_mov_b64 exec, 0xffff
    ds_write2_b32 v52, v94, v95 offset0:0 offset1:8
    ds_write2_b32 v52, v96, v97 offset0:16 offset1:24
    ds_write2_b32 v52, v98, v99 offset0:32 offset1:40
    ds_write2_b32 v52, v100, v101 offset0:48 offset1:56
    s_mov_b64 exec, -1
    s_waitcnt vmcnt(0)
    v_perm_b32 v62, v76, v80, s68
    v_perm_b32 v63, v68, v72, s68
    ds_write_b64 v54, v[62:63] offset:0
    v_perm_b32 v64, v76, v80, s69
    v_perm_b32 v65, v68, v72, s69
    ds_write_b64 v54, v[64:65] offset:4608
    v_perm_b32 v62, v77, v81, s68
    v_perm_b32 v63, v69, v73, s68
    ds_write_b64 v54, v[62:63] offset:9216
    v_perm_b32 v64, v77, v81, s69
    v_perm_b32 v65, v69, v73, s69
    ds_write_b64 v54, v[64:65] offset:13824
    v_perm_b32 v62, v78, v82, s68
    v_perm_b32 v63, v70, v74, s68
    ds_write_b64 v54, v[62:63] offset:18432
    v_perm_b32 v64, v78, v82, s69
    v_perm_b32 v65, v70, v74, s69
    ds_write_b64 v54, v[64:65] offset:23040
    s_waitcnt lgkmcnt(0)
    v_mov_b32 v62, 121872
    v_mov_b32 v63, 1
    s_cmp_lg_u32 s15, 0
    s_cbranch_scc1 L_A_noadd
    s_mov_b64 exec, 1
    ds_add_u32 v62, v63
    s_mov_b64 exec, -1
L_A_noadd:
    s_mov_b32 s75, 0
L_A_sp2:
    ds_read_b32 v63, v62 offset:0
    s_add_u32 s75, s75, 1
    s_waitcnt lgkmcnt(0)
    v_readfirstlane_b32 s3, v63
    s_nop 0
    s_cmp_eq_u32 s3, 4
    s_cbranch_scc1 L_A_sp2d
    s_sleep 1
    s_cmp_lt_u32 s75, 0x400000
    s_cbranch_scc1 L_A_sp2
L_A_sp2d:
    s_cmp_eq_u32 s15, 0
    s_cbranch_scc1 L_A_cF
    s_setprio 1
    s_bitcmp1_b32 s6, 0
    s_cbranch_scc1 L_A_c1
    s_branch L_A_c0
L_A_cF:
    s_nop 0
    ds_read_b128 v[216:219], v44 offset:464
    ds_read_b128 v[220:223], v44 offset:448
    ds_read_b128 v[224:227], v44 offset:400
    ds_read_b128 v[228:231], v44 offset:336
    ds_read_b128 v[232:235], v44 offset:272
    s_waitcnt lgkmcnt(4)
    v_mfma_f32_16x16x32_bf16 v[92:95], v[148:151], v[216:219], 0
    ds_read2_b32 v[52:53], v49 offset0:65 offset1:63
    v_mfma_f32_16x16x32_bf16 v[96:99], v[180:183], v[216:219], 0
    ds_read2_b32 v[54:55], v49 offset0:130 offset1:128
    v_mfma_f32_16x16x32_bf16 v[2:5], v[216:219], v[16:19], 0
    ds_read2_b32 v[56:57], v49 offset0:194 offset1:192
    v_mfma_f32_16x16x32_bf16 v[6:9], v[216:219], v[20:23], 0
    ds_read2_b32 v[58:59], v49 offset0:2 offset1:0
    v_mfma_f32_16x16x32_bf16 v[10:13], v[216:219], v[24:27], 0
    ds_read2_b32 v[60:61], v49 offset0:81 offset1:79
    v_mfma_f32_16x16x32_bf16 v[128:131], v[216:219], v[32:35], 0
    ds_read2_b32 v[62:63], v49 offset0:146 offset1:144
    v_mfma_f32_16x16x32_bf16 v[100:103], v[212:215], v[216:219], 0
    ds_read2_b32 v[64:65], v49 offset0:210 offset1:208
    v_mfma_f32_16x16x32_bf16 v[108:111], v[40:43], v[216:219], 0
    ds_read2_b32 v[66:67], v49 offset0:18 offset1:16
    ds_read_b128 v[236:239], v44 offset:208
    s_waitcnt lgkmcnt(12)
    v_mfma_f32_16x16x32_bf16 v[124:127], v[220:223], v[28:31], 0
    ds_read2_b32 v[68:69], v49 offset0:97 offset1:95
    v_mfma_f32_16x16x32_bf16 v[140:143], v[220:223], v[36:39], 0
    ds_read2_b32 v[70:71], v49 offset0:162 offset1:160
    ds_read_b128 v[216:219], v44 offset:144
    s_waitcnt lgkmcnt(14)
    v_mfma_f32_16x16x32_bf16 v[92:95], v[152:155], v[224:227], v[92:95]
    ds_read2_b32 v[72:73], v49 offset0:226 offset1:224
    v_mfma_f32_16x16x32_bf16 v[96:99], v[184:187], v[224:227], v[96:99]
    ds_read2_b32 v[74:75], v49 offset0:34 offset1:32
    ds_read_b128 v[220:223], v44 offset:80
    s_waitcnt lgkmcnt(15)
    v_mfma_f32_16x16x32_bf16 v[92:95], v[156:159], v[228:231], v[92:95]
    ds_read2_b32 v[76:77], v50 offset0:2 offset1:0
    v_mfma_f32_16x16x32_bf16 v[96:99], v[188:191], v[228:231], v[96:99]
    ds_read2_b32 v[78:79], v50 offset0:82 offset1:80
    ds_read_b128 v[224:227], v44 offset:16
    v_cvt_pk_bf16_f32 v144, v2, v3
    v_cvt_pk_bf16_f32 v145, v4, v5
    v_cvt_pk_bf16_f32 v146, v6, v7
    v_cvt_pk_bf16_f32 v147, v8, v9
    v_mfma_f32_16x16x32_bf16 v[92:95], v[160:163], v[232:235], v[92:95]
    ds_read2_b32 v[80:81], v50 offset0:18 offset1:16
    v_mfma_f32_16x16x32_bf16 v[96:99], v[192:195], v[232:235], v[96:99]
    ds_read2_b32 v[82:83], v50 offset0:98 offset1:96
    ds_read_b128 v[228:231], v44 offset:976
    v_cvt_pk_bf16_f32 v240, v10, v11
    v_cvt_pk_bf16_f32 v241, v12, v13
    v_cvt_pk_bf16_f32 v242, v124, v125
    v_cvt_pk_bf16_f32 v243, v126, v127
    s_waitcnt lgkmcnt(12)
    v_mfma_f32_16x16x32_bf16 v[92:95], v[164:167], v[236:239], v[92:95]
    ds_read2_b32 v[84:85], v50 offset0:34 offset1:32
    v_mfma_f32_16x16x32_bf16 v[96:99], v[196:199], v[236:239], v[96:99]
    ds_read2_b32 v[86:87], v50 offset0:114 offset1:112
    ds_read_b128 v[232:235], v44 offset:960
    v_cvt_pk_bf16_f32 v244, v128, v129
    v_cvt_pk_bf16_f32 v245, v130, v131
    v_cvt_pk_bf16_f32 v246, v140, v141
    v_cvt_pk_bf16_f32 v247, v142, v143
    s_waitcnt lgkmcnt(12)
    v_mfma_f32_16x16x32_bf16 v[92:95], v[168:171], v[216:219], v[92:95]
    ds_read2_b32 v[88:89], v50 offset0:50 offset1:48
    v_mfma_f32_16x16x32_bf16 v[96:99], v[200:203], v[216:219], v[96:99]
    ds_read2_b32 v[90:91], v50 offset0:130 offset1:128
    ds_read_b128 v[236:239], v44 offset:912
    s_waitcnt lgkmcnt(13)
    v_mfma_f32_16x16x32_bf16 v[100:103], v[144:147], v[52:55], v[100:103]
    v_mfma_f32_16x16x32_bf16 v[104:107], v[144:147], v[60:63], 0
    v_mfma_f32_16x16x32_bf16 v[108:111], v[144:147], v[68:71], v[108:111]
    s_waitcnt lgkmcnt(12)
    v_mfma_f32_16x16x32_bf16 v[92:95], v[172:175], v[220:223], v[92:95]
    v_mfma_f32_16x16x32_bf16 v[96:99], v[204:207], v[220:223], v[96:99]
    ds_read_b128 v[216:219], v44 offset:848
    v_mfma_f32_16x16x32_bf16 v[100:103], v[240:243], v[56:59], v[100:103]
    v_mfma_f32_16x16x32_bf16 v[104:107], v[240:243], v[64:67], v[104:107]
    v_mfma_f32_16x16x32_bf16 v[108:111], v[240:243], v[72:75], v[108:111]
    s_waitcnt lgkmcnt(10)
    v_mfma_f32_16x16x32_bf16 v[92:95], v[176:179], v[224:227], v[92:95]
    v_mfma_f32_16x16x32_bf16 v[96:99], v[208:211], v[224:227], v[96:99]
    ds_read_b128 v[220:223], v44 offset:784
    s_waitcnt lgkmcnt(3)
    v_mfma_f32_16x16x32_bf16 v[108:111], v[244:247], v[76:79], v[108:111]
    v_mfma_f32_16x16x32_bf16 v[112:115], v[244:247], v[80:83], 0
    v_mfma_f32_16x16x32_bf16 v[116:119], v[244:247], v[84:87], 0
    v_mfma_f32_16x16x32_bf16 v[120:123], v[244:247], v[88:91], 0
    v_mfma_f32_16x16x32_bf16 v[96:99], v[148:151], v[228:231], v[96:99]
    v_mfma_f32_16x16x32_bf16 v[100:103], v[180:183], v[228:231], v[100:103]
    v_mfma_f32_16x16x32_bf16 v[2:5], v[228:231], v[16:19], 0
    v_mfma_f32_16x16x32_bf16 v[6:9], v[228:231], v[20:23], 0
    v_mfma_f32_16x16x32_bf16 v[10:13], v[228:231], v[24:27], 0
    v_mfma_f32_16x16x32_bf16 v[128:131], v[228:231], v[32:35], 0
    v_mfma_f32_16x16x32_bf16 v[104:107], v[212:215], v[228:231], v[104:107]
    v_mfma_f32_16x16x32_bf16 v[112:115], v[40:43], v[228:231], v[112:115]
    ds_read_b128 v[224:227], v44 offset:720
    v_mfma_f32_16x16x32_bf16 v[124:127], v[232:235], v[28:31], 0
    v_mfma_f32_16x16x32_bf16 v[140:143], v[232:235], v[36:39], 0
    ds_read_b128 v[228:231], v44 offset:656
    s_waitcnt lgkmcnt(4)
    v_mfma_f32_16x16x32_bf16 v[96:99], v[152:155], v[236:239], v[96:99]
    v_mfma_f32_16x16x32_bf16 v[100:103], v[184:187], v[236:239], v[100:103]
    ds_read_b128 v[232:235], v44 offset:592
    ds_write_b128 v45, v[92:95] offset:0
    s_waitcnt lgkmcnt(5)
    v_mfma_f32_16x16x32_bf16 v[96:99], v[156:159], v[216:219], v[96:99]
    v_mfma_f32_16x16x32_bf16 v[100:103], v[188:191], v[216:219], v[100:103]
    ds_read_b128 v[236:239], v44 offset:528
    v_cvt_pk_bf16_f32 v144, v2, v3
    v_cvt_pk_bf16_f32 v145, v4, v5
    v_cvt_pk_bf16_f32 v146, v6, v7
    v_cvt_pk_bf16_f32 v147, v8, v9
    s_waitcnt lgkmcnt(5)
    v_mfma_f32_16x16x32_bf16 v[96:99], v[160:163], v[220:223], v[96:99]
    v_mfma_f32_16x16x32_bf16 v[100:103], v[192:195], v[220:223], v[100:103]
    ds_read_b128 v[216:219], v44 offset:1488
    v_cvt_pk_bf16_f32 v240, v10, v11
    v_cvt_pk_bf16_f32 v241, v12, v13
    v_cvt_pk_bf16_f32 v242, v124, v125
    v_cvt_pk_bf16_f32 v243, v126, v127
    s_waitcnt lgkmcnt(5)
    v_mfma_f32_16x16x32_bf16 v[96:99], v[164:167], v[224:227], v[96:99]
    v_mfma_f32_16x16x32_bf16 v[100:103], v[196:199], v[224:227], v[100:103]
    ds_read_b128 v[220:223], v44 offset:1472
    v_cvt_pk_bf16_f32 v244, v128, v129
    v_cvt_pk_bf16_f32 v245, v130, v131
    v_cvt_pk_bf16_f32 v246, v140, v141
    v_cvt_pk_bf16_f32 v247, v142, v143
    v_mfma_f32_16x16x32_bf16 v[104:107], v[144:147], v[52:55], v[104:107]
    v_mfma_f32_16x16x32_bf16 v[108:111], v[144:147], v[60:63], v[108:111]
    v_mfma_f32_16x16x32_bf16 v[112:115], v[144:147], v[68:71], v[112:115]
    s_waitcnt lgkmcnt(5)
    v_mfma_f32_16x16x32_bf16 v[96:99], v[168:171], v[228:231], v[96:99]
    v_mfma_f32_16x16x32_bf16 v[100:103], v[200:203], v[228:231], v[100:103]
    ds_read_b128 v[224:227], v44 offset:1424
    v_mfma_f32_16x16x32_bf16 v[104:107], v[240:243], v[56:59], v[104:107]
    v_mfma_f32_16x16x32_bf16 v[108:111], v[240:243], v[64:67], v[108:111]
    v_mfma_f32_16x16x32_bf16 v[112:115], v[240:243], v[72:75], v[112:115]
    s_waitcnt lgkmcnt(5)
    v_mfma_f32_16x16x32_bf16 v[96:99], v[172:175], v[232:235], v[96:99]
    v_mfma_f32_16x16x32_bf16 v[100:103], v[204:207], v[232:235], v[100:103]
    ds_read_b128 v[228:231], v44 offset:1360
    v_mfma_f32_16x16x32_bf16 v[112:115], v[244:247], v[76:79], v[112:115]
    v_mfma_f32_16x16x32_bf16 v[116:119], v[244:247], v[80:83], v[116:119]
    v_mfma_f32_16x16x32_bf16 v[120:123], v[244:247], v[84:87], v[120:123]
    s_waitcnt lgkmcnt(4)
    v_mfma_f32_16x16x32_bf16 v[96:99], v[176:179], v[236:239], v[96:99]
    v_mfma_f32_16x16x32_bf16 v[100:103], v[208:211], v[236:239], v[100:103]
    ds_read_b128 v[232:235], v44 offset:1296
    s_waitcnt lgkmcnt(4)
    v_mfma_f32_16x16x32_bf16 v[100:103], v[148:151], v[216:219], v[100:103]
    v_mfma_f32_16x16x32_bf16 v[104:107], v[180:183], v[216:219], v[104:107]
    v_mfma_f32_16x16x32_bf16 v[2:5], v[216:219], v[16:19], 0
    v_mfma_f32_16x16x32_bf16 v[6:9], v[216:219], v[20:23], 0
    v_mfma_f32_16x16x32_bf16 v[10:13], v[216:219], v[24:27], 0
    v_mfma_f32_16x16x32_bf16 v[128:131], v[216:219], v[32:35], 0
    v_mfma_f32_16x16x32_bf16 v[108:111], v[212:215], v[216:219], v[108:111]
    v_mfma_f32_16x16x32_bf16 v[116:119], v[40:43], v[216:219], v[116:119]
    ds_read_b128 v[236:239], v44 offset:1232
    s_waitcnt lgkmcnt(4)
    v_mfma_f32_16x16x32_bf16 v[124:127], v[220:223], v[28:31], 0
    v_mfma_f32_16x16x32_bf16 v[140:143], v[220:223], v[36:39], 0
    ds_read_b128 v[216:219], v44 offset:1168
    s_waitcnt lgkmcnt(4)
    v_mfma_f32_16x16x32_bf16 v[100:103], v[152:155], v[224:227], v[100:103]
    v_mfma_f32_16x16x32_bf16 v[104:107], v[184:187], v[224:227], v[104:107]
    ds_read_b128 v[220:223], v44 offset:1104
    ds_write_b128 v45, v[96:99] offset:1280
    s_waitcnt lgkmcnt(5)
    v_mfma_f32_16x16x32_bf16 v[100:103], v[156:159], v[228:231], v[100:103]
    v_mfma_f32_16x16x32_bf16 v[104:107], v[188:191], v[228:231], v[104:107]
    ds_read_b128 v[224:227], v44 offset:1040
    v_cvt_pk_bf16_f32 v144, v2, v3
    v_cvt_pk_bf16_f32 v145, v4, v5
    v_cvt_pk_bf16_f32 v146, v6, v7
    v_cvt_pk_bf16_f32 v147, v8, v9
    s_waitcnt lgkmcnt(5)
    v_mfma_f32_16x16x32_bf16 v[100:103], v[160:163], v[232:235], v[100:103]
    v_mfma_f32_16x16x32_bf16 v[104:107], v[192:195], v[232:235], v[104:107]
    ds_read_b128 v[228:231], v44 offset:2000
    v_cvt_pk_bf16_f32 v240, v10, v11
    v_cvt_pk_bf16_f32 v241, v12, v13
    v_cvt_pk_bf16_f32 v242, v124, v125
    v_cvt_pk_bf16_f32 v243, v126, v127
    s_waitcnt lgkmcnt(5)
    v_mfma_f32_16x16x32_bf16 v[100:103], v[164:167], v[236:239], v[100:103]
    v_mfma_f32_16x16x32_bf16 v[104:107], v[196:199], v[236:239], v[104:107]
    ds_read_b128 v[232:235], v44 offset:1984
    v_cvt_pk_bf16_f32 v244, v128, v129
    v_cvt_pk_bf16_f32 v245, v130, v131
    v_cvt_pk_bf16_f32 v246, v140, v141
    v_cvt_pk_bf16_f32 v247, v142, v143
    v_mfma_f32_16x16x32_bf16 v[108:111], v[144:147], v[52:55], v[108:111]
    v_mfma_f32_16x16x32_bf16 v[112:115], v[144:147], v[60:63], v[112:115]
    v_mfma_f32_16x16x32_bf16 v[116:119], v[144:147], v[68:71], v[116:119]
    s_waitcnt lgkmcnt(5)
    v_mfma_f32_16x16x32_bf16 v[100:103], v[168:171], v[216:219], v[100:103]
    v_mfma_f32_16x16x32_bf16 v[104:107], v[200:203], v[216:219], v[104:107]
    ds_read_b128 v[236:239], v44 offset:1936
    v_mfma_f32_16x16x32_bf16 v[108:111], v[240:243], v[56:59], v[108:111]
    v_mfma_f32_16x16x32_bf16 v[112:115], v[240:243], v[64:67], v[112:115]
    v_mfma_f32_16x16x32_bf16 v[116:119], v[240:243], v[72:75], v[116:119]
    s_waitcnt lgkmcnt(5)
    v_mfma_f32_16x16x32_bf16 v[100:103], v[172:175], v[220:223], v[100:103]
    v_mfma_f32_16x16x32_bf16 v[104:107], v[204:207], v[220:223], v[104:107]
    ds_read_b128 v[216:219], v44 offset:1872
    v_mfma_f32_16x16x32_bf16 v[116:119], v[244:247], v[76:79], v[116:119]
    v_mfma_f32_16x16x32_bf16 v[120:123], v[244:247], v[80:83], v[120:123]
    s_waitcnt lgkmcnt(4)
    v_mfma_f32_16x16x32_bf16 v[100:103], v[176:179], v[224:227], v[100:103]
    v_mfma_f32_16x16x32_bf16 v[104:107], v[208:211], v[224:227], v[104:107]
    ds_read_b128 v[220:223], v44 offset:1808
    s_waitcnt lgkmcnt(4)
    v_mfma_f32_16x16x32_bf16 v[104:107], v[148:151], v[228:231], v[104:107]
    v_mfma_f32_16x16x32_bf16 v[108:111], v[180:183], v[228:231], v[108:111]
    v_mfma_f32_16x16x32_bf16 v[2:5], v[228:231], v[16:19], 0
    v_mfma_f32_16x16x32_bf16 v[6:9], v[228:231], v[20:23], 0
    v_mfma_f32_16x16x32_bf16 v[10:13], v[228:231], v[24:27], 0
    v_mfma_f32_16x16x32_bf16 v[128:131], v[228:231], v[32:35], 0
    v_mfma_f32_16x16x32_bf16 v[112:115], v[212:215], v[228:231], v[112:115]
    v_mfma_f32_16x16x32_bf16 v[120:123], v[40:43], v[228:231], v[120:123]
    ds_read_b128 v[224:227], v44 offset:1744
    s_waitcnt lgkmcnt(4)
    v_mfma_f32_16x16x32_bf16 v[124:127], v[232:235], v[28:31], 0
    v_mfma_f32_16x16x32_bf16 v[140:143], v[232:235], v[36:39], 0
    ds_read_b128 v[228:231], v44 offset:1680
    s_waitcnt lgkmcnt(4)
    v_mfma_f32_16x16x32_bf16 v[104:107], v[152:155], v[236:239], v[104:107]
    v_mfma_f32_16x16x32_bf16 v[108:111], v[184:187], v[236:239], v[108:111]
    ds_read_b128 v[232:235], v44 offset:1616
    ds_write_b128 v45, v[100:103] offset:2560
    s_waitcnt lgkmcnt(0)
    s_barrier
    ds_read2st64_b32 v[132:133], v46 offset0:0 offset1:34
    ds_read2st64_b32 v[134:135], v46 offset0:68 offset1:102
    ds_read2st64_b32 v[136:137], v47 offset0:136 offset1:204
    v_mfma_f32_16x16x32_bf16 v[104:107], v[156:159], v[216:219], v[104:107]
    v_mfma_f32_16x16x32_bf16 v[108:111], v[188:191], v[216:219], v[108:111]
    ds_read_b128 v[236:239], v44 offset:1552
    v_cvt_pk_bf16_f32 v144, v2, v3
    v_cvt_pk_bf16_f32 v145, v4, v5
    v_cvt_pk_bf16_f32 v146, v6, v7
    v_cvt_pk_bf16_f32 v147, v8, v9
    v_mfma_f32_16x16x32_bf16 v[104:107], v[160:163], v[220:223], v[104:107]
    v_mfma_f32_16x16x32_bf16 v[108:111], v[192:195], v[220:223], v[108:111]
    ds_read_b128 v[216:219], v44 offset:2512
    v_cvt_pk_bf16_f32 v240, v10, v11
    v_cvt_pk_bf16_f32 v241, v12, v13
    v_cvt_pk_bf16_f32 v242, v124, v125
    v_cvt_pk_bf16_f32 v243, v126, v127
    s_waitcnt lgkmcnt(2)
    v_cvt_pk_bf16_f32 v132, v132, v133
    v_cvt_pk_bf16_f32 v133, v134, v135
    v_cvt_pk_bf16_f32 v134, v136, v137
    buffer_store_dwordx3 v[132:134], v48, s[60:63], s76 offen
    s_add_u32 s76, s76, s77
    v_mfma_f32_16x16x32_bf16 v[104:107], v[164:167], v[224:227], v[104:107]
    v_mfma_f32_16x16x32_bf16 v[108:111], v[196:199], v[224:227], v[108:111]
    ds_read_b128 v[220:223], v44 offset:2496
    v_cvt_pk_bf16_f32 v244, v128, v129
    v_cvt_pk_bf16_f32 v245, v130, v131
    v_cvt_pk_bf16_f32 v246, v140, v141
    v_cvt_pk_bf16_f32 v247, v142, v143
    v_mfma_f32_16x16x32_bf16 v[112:115], v[144:147], v[52:55], v[112:115]
    v_mfma_f32_16x16x32_bf16 v[116:119], v[144:147], v[60:63], v[116:119]
    v_mfma_f32_16x16x32_bf16 v[120:123], v[144:147], v[68:71], v[120:123]
    v_mfma_f32_16x16x32_bf16 v[104:107], v[168:171], v[228:231], v[104:107]
    v_mfma_f32_16x16x32_bf16 v[108:111], v[200:203], v[228:231], v[108:111]
    ds_read_b128 v[224:227], v44 offset:2448
    v_mfma_f32_16x16x32_bf16 v[112:115], v[240:243], v[56:59], v[112:115]
    v_mfma_f32_16x16x32_bf16 v[116:119], v[240:243], v[64:67], v[116:119]
    v_mfma_f32_16x16x32_bf16 v[120:123], v[240:243], v[72:75], v[120:123]
    v_mfma_f32_16x16x32_bf16 v[104:107], v[172:175], v[232:235], v[104:107]
    v_mfma_f32_16x16x32_bf16 v[108:111], v[204:207], v[232:235], v[108:111]
    ds_read_b128 v[228:231], v44 offset:2384
    v_mfma_f32_16x16x32_bf16 v[120:123], v[244:247], v[76:79], v[120:123]
    s_waitcnt lgkmcnt(4)
    v_mfma_f32_16x16x32_bf16 v[104:107], v[176:179], v[236:239], v[104:107]
    v_mfma_f32_16x16x32_bf16 v[108:111], v[208:211], v[236:239], v[108:111]
    ds_read_b128 v[232:235], v44 offset:2320
    s_waitcnt lgkmcnt(4)
    v_mfma_f32_16x16x32_bf16 v[108:111], v[148:151], v[216:219], v[108:111]
    v_mfma_f32_16x16x32_bf16 v[112:115], v[180:183], v[216:219], v[112:115]
    v_mfma_f32_16x16x32_bf16 v[2:5], v[216:219], v[16:19], 0
    v_mfma_f32_16x16x32_bf16 v[6:9], v[216:219], v[20:23], 0
    v_mfma_f32_16x16x32_bf16 v[10:13], v[216:219], v[24:27], 0
    v_mfma_f32_16x16x32_bf16 v[116:119], v[212:215], v[216:219], v[116:119]
    ds_read_b128 v[236:239], v44 offset:2256
    s_waitcnt lgkmcnt(4)
    v_mfma_f32_16x16x32_bf16 v[124:127], v[220:223], v[28:31], 0
    ds_read_b128 v[216:219], v44 offset:2192
    s_waitcnt lgkmcnt(4)
    v_mfma_f32_16x16x32_bf16 v[108:111], v[152:155], v[224:227], v[108:111]
    v_mfma_f32_16x16x32_bf16 v[112:115], v[184:187], v[224:227], v[112:115]
    ds_read_b128 v[220:223], v44 offset:2128
    ds_write_b128 v45, v[104:107] offset:3840
    s_waitcnt lgkmcnt(5)
    v_mfma_f32_16x16x32_bf16 v[108:111], v[156:159], v[228:231], v[108:111]
    v_mfma_f32_16x16x32_bf16 v[112:115], v[188:191], v[228:231], v[112:115]
    ds_read_b128 v[224:227], v44 offset:2064
    v_cvt_pk_bf16_f32 v144, v2, v3
    v_cvt_pk_bf16_f32 v145, v4, v5
    v_cvt_pk_bf16_f32 v146, v6, v7
    v_cvt_pk_bf16_f32 v147, v8, v9
    s_waitcnt lgkmcnt(5)
    v_mfma_f32_16x16x32_bf16 v[108:111], v[160:163], v[232:235], v[108:111]
    v_mfma_f32_16x16x32_bf16 v[112:115], v[192:195], v[232:235], v[112:115]
    ds_read_b128 v[228:231], v44 offset:3024
    v_cvt_pk_bf16_f32 v240, v10, v11
    v_cvt_pk_bf16_f32 v241, v12, v13
    v_cvt_pk_bf16_f32 v242, v124, v125
    v_cvt_pk_bf16_f32 v243, v126, v127
    s_waitcnt lgkmcnt(2)
    s_barrier
    ds_read2st64_b32 v[132:133], v46 offset0:10 offset1:44
    ds_read2st64_b32 v[134:135], v46 offset0:78 offset1:112
    ds_read2st64_b32 v[136:137], v47 offset0:141 offset1:209
    v_mfma_f32_16x16x32_bf16 v[108:111], v[164:167], v[236:239], v[108:111]
    v_mfma_f32_16x16x32_bf16 v[112:115], v[196:199], v[236:239], v[112:115]
    ds_read_b128 v[232:235], v44 offset:3008
    v_mfma_f32_16x16x32_bf16 v[116:119], v[144:147], v[52:55], v[116:119]
    v_mfma_f32_16x16x32_bf16 v[120:123], v[144:147], v[60:63], v[120:123]
    v_mfma_f32_16x16x32_bf16 v[108:111], v[168:171], v[216:219], v[108:111]
    v_mfma_f32_16x16x32_bf16 v[112:115], v[200:203], v[216:219], v[112:115]
    ds_read_b128 v[236:239], v44 offset:2960
    v_mfma_f32_16x16x32_bf16 v[116:119], v[240:243], v[56:59], v[116:119]
    v_mfma_f32_16x16x32_bf16 v[120:123], v[240:243], v[64:67], v[120:123]
    s_waitcnt lgkmcnt(2)
    v_cvt_pk_bf16_f32 v132, v132, v133
    v_cvt_pk_bf16_f32 v133, v134, v135
    v_cvt_pk_bf16_f32 v134, v136, v137
    buffer_store_dwordx3 v[132:134], v48, s[60:63], s76 offen
    s_add_u32 s76, s76, s77
    v_mfma_f32_16x16x32_bf16 v[108:111], v[172:175], v[220:223], v[108:111]
    v_mfma_f32_16x16x32_bf16 v[112:115], v[204:207], v[220:223], v[112:115]
    ds_read_b128 v[216:219], v44 offset:2896
    v_mfma_f32_16x16x32_bf16 v[108:111], v[176:179], v[224:227], v[108:111]
    v_mfma_f32_16x16x32_bf16 v[112:115], v[208:211], v[224:227], v[112:115]
    ds_read_b128 v[220:223], v44 offset:2832
    v_mfma_f32_16x16x32_bf16 v[112:115], v[148:151], v[228:231], v[112:115]
    v_mfma_f32_16x16x32_bf16 v[116:119], v[180:183], v[228:231], v[116:119]
    v_mfma_f32_16x16x32_bf16 v[2:5], v[228:231], v[16:19], 0
    v_mfma_f32_16x16x32_bf16 v[6:9], v[228:231], v[20:23], 0
    v_mfma_f32_16x16x32_bf16 v[10:13], v[228:231], v[24:27], 0
    v_mfma_f32_16x16x32_bf16 v[120:123], v[212:215], v[228:231], v[120:123]
    ds_read_b128 v[224:227], v44 offset:2768
    s_waitcnt lgkmcnt(4)
    v_mfma_f32_16x16x32_bf16 v[124:127], v[232:235], v[28:31], 0
    ds_read_b128 v[228:231], v44 offset:2704
    s_waitcnt lgkmcnt(4)
    v_mfma_f32_16x16x32_bf16 v[112:115], v[152:155], v[236:239], v[112:115]
    v_mfma_f32_16x16x32_bf16 v[116:119], v[184:187], v[236:239], v[116:119]
    ds_read_b128 v[232:235], v44 offset:2640
    ds_write_b128 v45, v[108:111] offset:5120
    s_waitcnt lgkmcnt(5)
    v_mfma_f32_16x16x32_bf16 v[112:115], v[156:159], v[216:219], v[112:115]
    v_mfma_f32_16x16x32_bf16 v[116:119], v[188:191], v[216:219], v[116:119]
    ds_read_b128 v[236:239], v44 offset:2576
    v_cvt_pk_bf16_f32 v144, v2, v3
    v_cvt_pk_bf16_f32 v145, v4, v5
    v_cvt_pk_bf16_f32 v146, v6, v7
    v_cvt_pk_bf16_f32 v147, v8, v9
    s_waitcnt lgkmcnt(5)
    v_mfma_f32_16x16x32_bf16 v[112:115], v[160:163], v[220:223], v[112:115]
    v_mfma_f32_16x16x32_bf16 v[116:119], v[192:195], v[220:223], v[116:119]
    ds_read_b128 v[216:219], v44 offset:3536
    v_cvt_pk_bf16_f32 v240, v10, v11
    v_cvt_pk_bf16_f32 v241, v12, v13
    v_cvt_pk_bf16_f32 v242, v124, v125
    v_cvt_pk_bf16_f32 v243, v126, v127
    s_waitcnt lgkmcnt(5)
    v_mfma_f32_16x16x32_bf16 v[112:115], v[164:167], v[224:227], v[112:115]
    v_mfma_f32_16x16x32_bf16 v[116:119], v[196:199], v[224:227], v[116:119]
    ds_read_b128 v[220:223], v44 offset:3472
    v_mfma_f32_16x16x32_bf16 v[120:123], v[144:147], v[52:55], v[120:123]
    s_waitcnt lgkmcnt(5)
    v_mfma_f32_16x16x32_bf16 v[112:115], v[168:171], v[228:231], v[112:115]
    v_mfma_f32_16x16x32_bf16 v[116:119], v[200:203], v[228:231], v[116:119]
    ds_read_b128 v[224:227], v44 offset:3408
    v_mfma_f32_16x16x32_bf16 v[120:123], v[240:243], v[56:59], v[120:123]
    s_waitcnt lgkmcnt(5)
    v_mfma_f32_16x16x32_bf16 v[112:115], v[172:175], v[232:235], v[112:115]
    v_mfma_f32_16x16x32_bf16 v[116:119], v[204:207], v[232:235], v[116:119]
    ds_read_b128 v[228:231], v44 offset:3344
    s_waitcnt lgkmcnt(4)
    v_mfma_f32_16x16x32_bf16 v[112:115], v[176:179], v[236:239], v[112:115]
    v_mfma_f32_16x16x32_bf16 v[116:119], v[208:211], v[236:239], v[116:119]
    ds_read_b128 v[232:235], v44 offset:3280
    s_waitcnt lgkmcnt(4)
    v_mfma_f32_16x16x32_bf16 v[116:119], v[148:151], v[216:219], v[116:119]
    v_mfma_f32_16x16x32_bf16 v[120:123], v[180:183], v[216:219], v[120:123]
    ds_read_b128 v[236:239], v44 offset:3216
    s_waitcnt lgkmcnt(4)
    v_mfma_f32_16x16x32_bf16 v[116:119], v[152:155], v[220:223], v[116:119]
    v_mfma_f32_16x16x32_bf16 v[120:123], v[184:187], v[220:223], v[120:123]
    ds_read_b128 v[216:219], v44 offset:3152
    ds_write_b128 v45, v[112:115] offset:6400
    s_waitcnt lgkmcnt(5)
    v_mfma_f32_16x16x32_bf16 v[116:119], v[156:159], v[224:227], v[116:119]
    v_mfma_f32_16x16x32_bf16 v[120:123], v[188:191], v[224:227], v[120:123]
    ds_read_b128 v[220:223], v44 offset:3088
    s_waitcnt lgkmcnt(5)
    v_mfma_f32_16x16x32_bf16 v[116:119], v[160:163], v[228:231], v[116:119]
    v_mfma_f32_16x16x32_bf16 v[120:123], v[192:195], v[228:231], v[120:123]
    ds_read_b128 v[224:227], v44 offset:4048
    s_waitcnt lgkmcnt(2)
    s_barrier
    ds_read2st64_b32 v[132:133], v46 offset0:20 offset1:54
    ds_read2st64_b32 v[134:135], v46 offset0:88 offset1:122
    ds_read2st64_b32 v[136:137], v47 offset0:146 offset1:214
    v_mfma_f32_16x16x32_bf16 v[116:119], v[164:167], v[232:235], v[116:119]
    v_mfma_f32_16x16x32_bf16 v[120:123], v[196:199], v[232:235], v[120:123]
    ds_read_b128 v[228:231], v44 offset:3984
    v_mfma_f32_16x16x32_bf16 v[116:119], v[168:171], v[236:239], v[116:119]
    v_mfma_f32_16x16x32_bf16 v[120:123], v[200:203], v[236:239], v[120:123]
    ds_read_b128 v[232:235], v44 offset:3920
    s_waitcnt lgkmcnt(2)
    v_cvt_pk_bf16_f32 v132, v132, v133
    v_cvt_pk_bf16_f32 v133, v134, v135
    v_cvt_pk_bf16_f32 v134, v136, v137
    buffer_store_dwordx3 v[132:134], v48, s[60:63], s76 offen
    s_add_u32 s76, s76, s77
    v_mfma_f32_16x16x32_bf16 v[116:119], v[172:175], v[216:219], v[116:119]
    v_mfma_f32_16x16x32_bf16 v[120:123], v[204:207], v[216:219], v[120:123]
    ds_read_b128 v[236:239], v44 offset:3856
    v_mfma_f32_16x16x32_bf16 v[116:119], v[176:179], v[220:223], v[116:119]
    v_mfma_f32_16x16x32_bf16 v[120:123], v[208:211], v[220:223], v[120:123]
    ds_read_b128 v[216:219], v44 offset:3792
    v_mfma_f32_16x16x32_bf16 v[120:123], v[148:151], v[224:227], v[120:123]
    ds_read_b128 v[220:223], v44 offset:3728
    s_waitcnt lgkmcnt(4)
    v_mfma_f32_16x16x32_bf16 v[120:123], v[152:155], v[228:231], v[120:123]
    ds_read_b128 v[224:227], v44 offset:3664
    s_nop 0
    ds_write_b128 v45, v[116:119] offset:0
    s_waitcnt lgkmcnt(5)
    v_mfma_f32_16x16x32_bf16 v[120:123], v[156:159], v[232:235], v[120:123]
    ds_read_b128 v[228:231], v44 offset:3600
    s_waitcnt lgkmcnt(5)
    v_mfma_f32_16x16x32_bf16 v[120:123], v[160:163], v[236:239], v[120:123]
    s_waitcnt lgkmcnt(1)
    s_barrier
    s_mov_b32 exec_lo, 0xffffffff
    s_mov_b32 exec_hi, 0x0
    ds_read2st64_b32 v[132:133], v46 offset0:0 offset1:34
    ds_read2st64_b32 v[134:135], v46 offset0:68 offset1:102
    ds_read2st64_b32 v[136:137], v47 offset0:151 offset1:219
    s_mov_b64 exec, -1
    v_mfma_f32_16x16x32_bf16 v[120:123], v[164:167], v[216:219], v[120:123]
    v_mfma_f32_16x16x32_bf16 v[120:123], v[168:171], v[220:223], v[120:123]
    s_waitcnt lgkmcnt(0)
    v_cvt_pk_bf16_f32 v132, v132, v133
    v_cvt_pk_bf16_f32 v133, v134, v135
    v_cvt_pk_bf16_f32 v134, v136, v137
    s_mov_b32 exec_lo, 0xffffffff
    s_mov_b32 exec_hi, 0x0
    buffer_store_dwordx3 v[132:134], v48, s[60:63], s76 offen
    s_mov_b64 exec, -1
    v_mfma_f32_16x16x32_bf16 v[120:123], v[172:175], v[224:227], v[120:123]
    v_mfma_f32_16x16x32_bf16 v[120:123], v[176:179], v[228:231], v[120:123]
    s_nop 7
    ds_write_b128 v45, v[120:123] offset:1280
    s_waitcnt lgkmcnt(0)
    s_barrier
    s_mov_b32 exec_lo, 0x0
    s_mov_b32 exec_hi, 0xffffffff
    ds_read2st64_b32 v[132:133], v46 offset0:0 offset1:34
    ds_read2st64_b32 v[134:135], v46 offset0:68 offset1:102
    ds_read2st64_b32 v[136:137], v47 offset0:151 offset1:219
    s_mov_b64 exec, -1
    s_waitcnt lgkmcnt(0)
    v_cvt_pk_bf16_f32 v132, v132, v133
    v_cvt_pk_bf16_f32 v133, v134, v135
    v_cvt_pk_bf16_f32 v134, v136, v137
    s_mov_b32 exec_lo, 0x0
    s_mov_b32 exec_hi, 0xffffffff
    buffer_store_dwordx3 v[132:134], v48, s[60:63], s76 offen
    s_mov_b64 exec, -1
    s_endpgm
L_A_c0:
    s_nop 0
    ds_read_b128 v[216:219], v44 offset:464
    ds_read_b128 v[220:223], v44 offset:448
    ds_read_b128 v[224:227], v44 offset:400
    ds_read_b128 v[228:231], v44 offset:336
    ds_read_b128 v[232:235], v44 offset:272
    s_waitcnt lgkmcnt(4)
    v_mfma_f32_16x16x32_bf16 v[92:95], v[148:151], v[216:219], 0
    ds_read2_b32 v[52:53], v49 offset0:65 offset1:63
    v_mfma_f32_16x16x32_bf16 v[2:5], v[216:219], v[16:19], 0
    ds_read2_b32 v[54:55], v49 offset0:130 offset1:128
    v_mfma_f32_16x16x32_bf16 v[6:9], v[216:219], v[20:23], 0
    ds_read2_b32 v[56:57], v49 offset0:194 offset1:192
    v_mfma_f32_16x16x32_bf16 v[10:13], v[216:219], v[24:27], 0
    ds_read2_b32 v[58:59], v49 offset0:2 offset1:0
    v_mfma_f32_16x16x32_bf16 v[128:131], v[216:219], v[32:35], 0
    ds_read2_b32 v[60:61], v49 offset0:81 offset1:79
    v_mfma_f32_16x16x32_bf16 v[100:103], v[212:215], v[216:219], 0
    ds_read2_b32 v[62:63], v49 offset0:146 offset1:144
    v_mfma_f32_16x16x32_bf16 v[108:111], v[40:43], v[216:219], 0
    ds_read2_b32 v[64:65], v49 offset0:210 offset1:208
    ds_read_b128 v[236:239], v44 offset:208
    s_waitcnt lgkmcnt(11)
    v_mfma_f32_16x16x32_bf16 v[124:127], v[220:223], v[28:31], 0
    ds_read2_b32 v[66:67], v49 offset0:18 offset1:16
    v_mfma_f32_16x16x32_bf16 v[140:143], v[220:223], v[36:39], 0
    ds_read2_b32 v[68:69], v49 offset0:97 offset1:95
    ds_read_b128 v[216:219], v44 offset:144
    s_waitcnt lgkmcnt(13)
    v_mfma_f32_16x16x32_bf16 v[92:95], v[152:155], v[224:227], v[92:95]
    ds_read2_b32 v[70:71], v49 offset0:162 offset1:160
    ds_read_b128 v[220:223], v44 offset:80
    s_waitcnt lgkmcnt(14)
    v_mfma_f32_16x16x32_bf16 v[92:95], v[156:159], v[228:231], v[92:95]
    ds_read2_b32 v[72:73], v49 offset0:226 offset1:224
    ds_read_b128 v[224:227], v44 offset:16
    v_cvt_pk_bf16_f32 v144, v2, v3
    v_cvt_pk_bf16_f32 v145, v4, v5
    v_cvt_pk_bf16_f32 v146, v6, v7
    v_cvt_pk_bf16_f32 v147, v8, v9
    s_waitcnt lgkmcnt(15)
    v_mfma_f32_16x16x32_bf16 v[92:95], v[160:163], v[232:235], v[92:95]
    ds_read2_b32 v[74:75], v49 offset0:34 offset1:32
    ds_read_b128 v[228:231], v44 offset:976
    v_cvt_pk_bf16_f32 v240, v10, v11
    v_cvt_pk_bf16_f32 v241, v12, v13
    v_cvt_pk_bf16_f32 v242, v124, v125
    v_cvt_pk_bf16_f32 v243, v126, v127
    s_waitcnt lgkmcnt(9)
    v_mfma_f32_16x16x32_bf16 v[92:95], v[164:167], v[236:239], v[92:95]
    ds_read2_b32 v[76:77], v50 offset0:2 offset1:0
    ds_read_b128 v[232:235], v44 offset:960
    v_cvt_pk_bf16_f32 v244, v128, v129
    v_cvt_pk_bf16_f32 v245, v130, v131
    v_cvt_pk_bf16_f32 v246, v140, v141
    v_cvt_pk_bf16_f32 v247, v142, v143
    s_waitcnt lgkmcnt(8)
    v_mfma_f32_16x16x32_bf16 v[92:95], v[168:171], v[216:219], v[92:95]
    ds_read2_b32 v[78:79], v50 offset0:82 offset1:80
    ds_read_b128 v[236:239], v44 offset:912
    s_waitcnt lgkmcnt(5)
    v_mfma_f32_16x16x32_bf16 v[100:103], v[144:147], v[52:55], v[100:103]
    ds_read2_b32 v[80:81], v50 offset0:18 offset1:16
    v_mfma_f32_16x16x32_bf16 v[108:111], v[144:147], v[68:71], v[108:111]
    ds_read2_b32 v[82:83], v50 offset0:98 offset1:96
    v_mfma_f32_16x16x32_bf16 v[92:95], v[172:175], v[220:223], v[92:95]
    ds_read2_b32 v[84:85], v50 offset0:34 offset1:32
    ds_read_b128 v[216:219], v44 offset:848
    v_mfma_f32_16x16x32_bf16 v[100:103], v[240:243], v[56:59], v[100:103]
    ds_read2_b32 v[86:87], v50 offset0:114 offset1:112
    v_mfma_f32_16x16x32_bf16 v[108:111], v[240:243], v[72:75], v[108:111]
    ds_read2_b32 v[88:89], v50 offset0:50 offset1:48
    v_mfma_f32_16x16x32_bf16 v[92:95], v[176:179], v[224:227], v[92:95]
    ds_read2_b32 v[90:91], v50 offset0:130 offset1:128
    ds_read_b128 v[220:223], v44 offset:784
    s_waitcnt lgkmcnt(1)
    v_mfma_f32_16x16x32_bf16 v[108:111], v[244:247], v[76:79], v[108:111]
    v_mfma_f32_16x16x32_bf16 v[116:119], v[244:247], v[84:87], 0
    v_mfma_f32_16x16x32_bf16 v[100:103], v[180:183], v[228:231], v[100:103]
    v_mfma_f32_16x16x32_bf16 v[2:5], v[228:231], v[16:19], 0
    v_mfma_f32_16x16x32_bf16 v[6:9], v[228:231], v[20:23], 0
    v_mfma_f32_16x16x32_bf16 v[10:13], v[228:231], v[24:27], 0
    v_mfma_f32_16x16x32_bf16 v[128:131], v[228:231], v[32:35], 0
    ds_read_b128 v[224:227], v44 offset:720
    v_mfma_f32_16x16x32_bf16 v[124:127], v[232:235], v[28:31], 0
    v_mfma_f32_16x16x32_bf16 v[140:143], v[232:235], v[36:39], 0
    ds_read_b128 v[228:231], v44 offset:656
    v_mfma_f32_16x16x32_bf16 v[100:103], v[184:187], v[236:239], v[100:103]
    ds_read_b128 v[232:235], v44 offset:592
    ds_write_b128 v45, v[92:95] offset:0
    v_mfma_f32_16x16x32_bf16 v[100:103], v[188:191], v[216:219], v[100:103]
    ds_read_b128 v[236:239], v44 offset:528
    v_cvt_pk_bf16_f32 v144, v2, v3
    v_cvt_pk_bf16_f32 v145, v4, v5
    v_cvt_pk_bf16_f32 v146, v6, v7
    v_cvt_pk_bf16_f32 v147, v8, v9
    s_waitcnt lgkmcnt(5)
    v_mfma_f32_16x16x32_bf16 v[100:103], v[192:195], v[220:223], v[100:103]
    ds_read_b128 v[216:219], v44 offset:1488
    v_cvt_pk_bf16_f32 v240, v10, v11
    v_cvt_pk_bf16_f32 v241, v12, v13
    v_cvt_pk_bf16_f32 v242, v124, v125
    v_cvt_pk_bf16_f32 v243, v126, v127
    s_waitcnt lgkmcnt(5)
    v_mfma_f32_16x16x32_bf16 v[100:103], v[196:199], v[224:227], v[100:103]
    ds_read_b128 v[220:223], v44 offset:1472
    v_cvt_pk_bf16_f32 v244, v128, v129
    v_cvt_pk_bf16_f32 v245, v130, v131
    v_cvt_pk_bf16_f32 v246, v140, v141
    v_cvt_pk_bf16_f32 v247, v142, v143
    v_mfma_f32_16x16x32_bf16 v[108:111], v[144:147], v[60:63], v[108:111]
    s_waitcnt lgkmcnt(5)
    v_mfma_f32_16x16x32_bf16 v[100:103], v[200:203], v[228:231], v[100:103]
    ds_read_b128 v[224:227], v44 offset:1424
    v_mfma_f32_16x16x32_bf16 v[108:111], v[240:243], v[64:67], v[108:111]
    s_waitcnt lgkmcnt(5)
    v_mfma_f32_16x16x32_bf16 v[100:103], v[204:207], v[232:235], v[100:103]
    ds_read_b128 v[228:231], v44 offset:1360
    v_mfma_f32_16x16x32_bf16 v[116:119], v[244:247], v[80:83], v[116:119]
    s_waitcnt lgkmcnt(4)
    v_mfma_f32_16x16x32_bf16 v[100:103], v[208:211], v[236:239], v[100:103]
    ds_read_b128 v[232:235], v44 offset:1296
    s_waitcnt lgkmcnt(4)
    v_mfma_f32_16x16x32_bf16 v[100:103], v[148:151], v[216:219], v[100:103]
    v_mfma_f32_16x16x32_bf16 v[2:5], v[216:219], v[16:19], 0
    v_mfma_f32_16x16x32_bf16 v[6:9], v[216:219], v[20:23], 0
    v_mfma_f32_16x16x32_bf16 v[10:13], v[216:219], v[24:27], 0
    v_mfma_f32_16x16x32_bf16 v[128:131], v[216:219], v[32:35], 0
    v_mfma_f32_16x16x32_bf16 v[108:111], v[212:215], v[216:219], v[108:111]
    v_mfma_f32_16x16x32_bf16 v[116:119], v[40:43], v[216:219], v[116:119]
    ds_read_b128 v[236:239], v44 offset:1232
    s_waitcnt lgkmcnt(4)
    v_mfma_f32_16x16x32_bf16 v[124:127], v[220:223], v[28:31], 0
    v_mfma_f32_16x16x32_bf16 v[140:143], v[220:223], v[36:39], 0
    ds_read_b128 v[216:219], v44 offset:1168
    s_waitcnt lgkmcnt(4)
    v_mfma_f32_16x16x32_bf16 v[100:103], v[152:155], v[224:227], v[100:103]
    ds_read_b128 v[220:223], v44 offset:1104
    s_waitcnt lgkmcnt(4)
    v_mfma_f32_16x16x32_bf16 v[100:103], v[156:159], v[228:231], v[100:103]
    ds_read_b128 v[224:227], v44 offset:1040
    v_cvt_pk_bf16_f32 v144, v2, v3
    v_cvt_pk_bf16_f32 v145, v4, v5
    v_cvt_pk_bf16_f32 v146, v6, v7
    v_cvt_pk_bf16_f32 v147, v8, v9
    s_waitcnt lgkmcnt(4)
    v_mfma_f32_16x16x32_bf16 v[100:103], v[160:163], v[232:235], v[100:103]
    ds_read_b128 v[228:231], v44 offset:2000
    v_cvt_pk_bf16_f32 v240, v10, v11
    v_cvt_pk_bf16_f32 v241, v12, v13
    v_cvt_pk_bf16_f32 v242, v124, v125
    v_cvt_pk_bf16_f32 v243, v126, v127
    s_waitcnt lgkmcnt(4)
    v_mfma_f32_16x16x32_bf16 v[100:103], v[164:167], v[236:239], v[100:103]
    ds_read_b128 v[232:235], v44 offset:1984
    v_cvt_pk_bf16_f32 v244, v128, v129
    v_cvt_pk_bf16_f32 v245, v130, v131
    v_cvt_pk_bf16_f32 v246, v140, v141
    v_cvt_pk_bf16_f32 v247, v142, v143
    v_mfma_f32_16x16x32_bf16 v[108:111], v[144:147], v[52:55], v[108:111]
    v_mfma_f32_16x16x32_bf16 v[116:119], v[144:147], v[68:71], v[116:119]
    s_waitcnt lgkmcnt(4)
    v_mfma_f32_16x16x32_bf16 v[100:103], v[168:171], v[216:219], v[100:103]
    ds_read_b128 v[236:239], v44 offset:1936
    v_mfma_f32_16x16x32_bf16 v[108:111], v[240:243], v[56:59], v[108:111]
    v_mfma_f32_16x16x32_bf16 v[116:119], v[240:243], v[72:75], v[116:119]
    s_waitcnt lgkmcnt(4)
    v_mfma_f32_16x16x32_bf16 v[100:103], v[172:175], v[220:223], v[100:103]
    ds_read_b128 v[216:219], v44 offset:1872
    v_mfma_f32_16x16x32_bf16 v[116:119], v[244:247], v[76:79], v[116:119]
    s_waitcnt lgkmcnt(4)
    v_mfma_f32_16x16x32_bf16 v[100:103], v[176:179], v[224:227], v[100:103]
    ds_read_b128 v[220:223], v44 offset:1808
    s_waitcnt lgkmcnt(4)
    v_mfma_f32_16x16x32_bf16 v[108:111], v[180:183], v[228:231], v[108:111]
    v_mfma_f32_16x16x32_bf16 v[2:5], v[228:231], v[16:19], 0
    v_mfma_f32_16x16x32_bf16 v[6:9], v[228:231], v[20:23], 0
    v_mfma_f32_16x16x32_bf16 v[10:13], v[228:231], v[24:27], 0
    ds_read_b128 v[224:227], v44 offset:1744
    s_waitcnt lgkmcnt(4)
    v_mfma_f32_16x16x32_bf16 v[124:127], v[232:235], v[28:31], 0
    ds_read_b128 v[228:231], v44 offset:1680
    s_waitcnt lgkmcnt(4)
    v_mfma_f32_16x16x32_bf16 v[108:111], v[184:187], v[236:239], v[108:111]
    ds_read_b128 v[232:235], v44 offset:1616
    ds_write_b128 v45, v[100:103] offset:1280
    s_waitcnt lgkmcnt(0)
    s_barrier
    ds_read2st64_b32 v[132:133], v46 offset0:0 offset1:34
    ds_read2st64_b32 v[134:135], v46 offset0:68 offset1:102
    ds_read2st64_b32 v[136:137], v47 offset0:136 offset1:204
    v_mfma_f32_16x16x32_bf16 v[108:111], v[188:191], v[216:219], v[108:111]
    ds_read_b128 v[236:239], v44 offset:1552
    v_cvt_pk_bf16_f32 v144, v2, v3
    v_cvt_pk_bf16_f32 v145, v4, v5
    v_cvt_pk_bf16_f32 v146, v6, v7
    v_cvt_pk_bf16_f32 v147, v8, v9
    v_mfma_f32_16x16x32_bf16 v[108:111], v[192:195], v[220:223], v[108:111]
    ds_read_b128 v[216:219], v44 offset:2512
    v_cvt_pk_bf16_f32 v240, v10, v11
    v_cvt_pk_bf16_f32 v241, v12, v13
    v_cvt_pk_bf16_f32 v242, v124, v125
    v_cvt_pk_bf16_f32 v243, v126, v127
    s_waitcnt lgkmcnt(2)
    v_cvt_pk_bf16_f32 v132, v132, v133
    v_cvt_pk_bf16_f32 v133, v134, v135
    v_cvt_pk_bf16_f32 v134, v136, v137
    buffer_store_dwordx3 v[132:134], v48, s[60:63], s76 offen
    s_add_u32 s76, s76, s77
    v_mfma_f32_16x16x32_bf16 v[108:111], v[196:199], v[224:227], v[108:111]
    ds_read_b128 v[220:223], v44 offset:2496
    v_mfma_f32_16x16x32_bf16 v[116:119], v[144:147], v[60:63], v[116:119]
    v_mfma_f32_16x16x32_bf16 v[108:111], v[200:203], v[228:231], v[108:111]
    ds_read_b128 v[224:227], v44 offset:2448
    v_mfma_f32_16x16x32_bf16 v[116:119], v[240:243], v[64:67], v[116:119]
    v_mfma_f32_16x16x32_bf16 v[108:111], v[204:207], v[232:235], v[108:111]
    ds_read_b128 v[228:231], v44 offset:2384
    s_waitcnt lgkmcnt(4)
    v_mfma_f32_16x16x32_bf16 v[108:111], v[208:211], v[236:239], v[108:111]
    ds_read_b128 v[232:235], v44 offset:2320
    s_waitcnt lgkmcnt(4)
    v_mfma_f32_16x16x32_bf16 v[108:111], v[148:151], v[216:219], v[108:111]
    v_mfma_f32_16x16x32_bf16 v[2:5], v[216:219], v[16:19], 0
    v_mfma_f32_16x16x32_bf16 v[6:9], v[216:219], v[20:23], 0
    v_mfma_f32_16x16x32_bf16 v[10:13], v[216:219], v[24:27], 0
    v_mfma_f32_16x16x32_bf16 v[116:119], v[212:215], v[216:219], v[116:119]
    ds_read_b128 v[236:239], v44 offset:2256
    s_waitcnt lgkmcnt(4)
    v_mfma_f32_16x16x32_bf16 v[124:127], v[220:223], v[28:31], 0
    ds_read_b128 v[216:219], v44 offset:2192
    s_waitcnt lgkmcnt(4)
    v_mfma_f32_16x16x32_bf16 v[108:111], v[152:155], v[224:227], v[108:111]
    ds_read_b128 v[220:223], v44 offset:2128
    s_waitcnt lgkmcnt(4)
    v_mfma_f32_16x16x32_bf16 v[108:111], v[156:159], v[228:231], v[108:111]
    ds_read_b128 v[224:227], v44 offset:2064
    v_cvt_pk_bf16_f32 v144, v2, v3
    v_cvt_pk_bf16_f32 v145, v4, v5
    v_cvt_pk_bf16_f32 v146, v6, v7
    v_cvt_pk_bf16_f32 v147, v8, v9
    s_waitcnt lgkmcnt(4)
    v_mfma_f32_16x16x32_bf16 v[108:111], v[160:163], v[232:235], v[108:111]
    ds_read_b128 v[228:231], v44 offset:3024
    v_cvt_pk_bf16_f32 v240, v10, v11
    v_cvt_pk_bf16_f32 v241, v12, v13
    v_cvt_pk_bf16_f32 v242, v124, v125
    v_cvt_pk_bf16_f32 v243, v126, v127
    s_barrier
    ds_read2st64_b32 v[132:133], v46 offset0:10 offset1:44
    ds_read2st64_b32 v[134:135], v46 offset0:78 offset1:112
    ds_read2st64_b32 v[136:137], v47 offset0:141 offset1:209
    s_waitcnt lgkmcnt(7)
    v_mfma_f32_16x16x32_bf16 v[108:111], v[164:167], v[236:239], v[108:111]
    ds_read_b128 v[232:235], v44 offset:2960
    v_mfma_f32_16x16x32_bf16 v[116:119], v[144:147], v[52:55], v[116:119]
    s_waitcnt lgkmcnt(7)
    v_mfma_f32_16x16x32_bf16 v[108:111], v[168:171], v[216:219], v[108:111]
    ds_read_b128 v[236:239], v44 offset:2896
    v_mfma_f32_16x16x32_bf16 v[116:119], v[240:243], v[56:59], v[116:119]
    s_waitcnt lgkmcnt(2)
    v_cvt_pk_bf16_f32 v132, v132, v133
    v_cvt_pk_bf16_f32 v133, v134, v135
    v_cvt_pk_bf16_f32 v134, v136, v137
    buffer_store_dwordx3 v[132:134], v48, s[60:63], s76 offen
    s_add_u32 s76, s76, s77
    v_mfma_f32_16x16x32_bf16 v[108:111], v[172:175], v[220:223], v[108:111]
    ds_read_b128 v[216:219], v44 offset:2832
    v_mfma_f32_16x16x32_bf16 v[108:111], v[176:179], v[224:227], v[108:111]
    ds_read_b128 v[220:223], v44 offset:2768
    v_mfma_f32_16x16x32_bf16 v[116:119], v[180:183], v[228:231], v[116:119]
    ds_read_b128 v[224:227], v44 offset:2704
    s_waitcnt lgkmcnt(4)
    v_mfma_f32_16x16x32_bf16 v[116:119], v[184:187], v[232:235], v[116:119]
    ds_read_b128 v[228:231], v44 offset:2640
    s_nop 1
    ds_write_b128 v45, v[108:111] offset:2560
    s_waitcnt lgkmcnt(5)
    v_mfma_f32_16x16x32_bf16 v[116:119], v[188:191], v[236:239], v[116:119]
    ds_read_b128 v[232:235], v44 offset:2576
    s_waitcnt lgkmcnt(5)
    v_mfma_f32_16x16x32_bf16 v[116:119], v[192:195], v[216:219], v[116:119]
    ds_read_b128 v[236:239], v44 offset:3536
    s_waitcnt lgkmcnt(5)
    v_mfma_f32_16x16x32_bf16 v[116:119], v[196:199], v[220:223], v[116:119]
    ds_read_b128 v[216:219], v44 offset:3472
    s_waitcnt lgkmcnt(5)
    v_mfma_f32_16x16x32_bf16 v[116:119], v[200:203], v[224:227], v[116:119]
    ds_read_b128 v[220:223], v44 offset:3408
    s_waitcnt lgkmcnt(5)
    v_mfma_f32_16x16x32_bf16 v[116:119], v[204:207], v[228:231], v[116:119]
    ds_read_b128 v[224:227], v44 offset:3344
    s_waitcnt lgkmcnt(4)
    v_mfma_f32_16x16x32_bf16 v[116:119], v[208:211], v[232:235], v[116:119]
    ds_read_b128 v[228:231], v44 offset:3280
    s_waitcnt lgkmcnt(4)
    v_mfma_f32_16x16x32_bf16 v[116:119], v[148:151], v[236:239], v[116:119]
    ds_read_b128 v[232:235], v44 offset:3216
    s_waitcnt lgkmcnt(4)
    v_mfma_f32_16x16x32_bf16 v[116:119], v[152:155], v[216:219], v[116:119]
    ds_read_b128 v[236:239], v44 offset:3152
    s_waitcnt lgkmcnt(4)
    v_mfma_f32_16x16x32_bf16 v[116:119], v[156:159], v[220:223], v[116:119]
    ds_read_b128 v[216:219], v44 offset:3088
    s_waitcnt lgkmcnt(4)
    v_mfma_f32_16x16x32_bf16 v[116:119], v[160:163], v[224:227], v[116:119]
    s_barrier
    ds_read2st64_b32 v[132:133], v46 offset0:20 offset1:54
    ds_read2st64_b32 v[134:135], v46 offset0:88 offset1:122
    ds_read2st64_b32 v[136:137], v47 offset0:146 offset1:214
    s_waitcnt lgkmcnt(6)
    v_mfma_f32_16x16x32_bf16 v[116:119], v[164:167], v[228:231], v[116:119]
    s_waitcnt lgkmcnt(5)
    v_mfma_f32_16x16x32_bf16 v[116:119], v[168:171], v[232:235], v[116:119]
    s_waitcnt lgkmcnt(0)
    v_cvt_pk_bf16_f32 v132, v132, v133
    v_cvt_pk_bf16_f32 v133, v134, v135
    v_cvt_pk_bf16_f32 v134, v136, v137
    buffer_store_dwordx3 v[132:134], v48, s[60:63], s76 offen
    s_add_u32 s76, s76, s77
    v_mfma_f32_16x16x32_bf16 v[116:119], v[172:175], v[236:239], v[116:119]
    v_mfma_f32_16x16x32_bf16 v[116:119], v[176:179], v[216:219], v[116:119]
    s_nop 7
    ds_write_b128 v45, v[116:119] offset:3840
    s_waitcnt lgkmcnt(0)
    s_barrier
    s_mov_b32 exec_lo, 0xffffffff
    s_mov_b32 exec_hi, 0x0
    ds_read2st64_b32 v[132:133], v46 offset0:0 offset1:34
    ds_read2st64_b32 v[134:135], v46 offset0:68 offset1:102
    ds_read2st64_b32 v[136:137], v47 offset0:151 offset1:219
    s_mov_b64 exec, -1
    s_waitcnt lgkmcnt(0)
    v_cvt_pk_bf16_f32 v132, v132, v133
    v_cvt_pk_bf16_f32 v133, v134, v135
    v_cvt_pk_bf16_f32 v134, v136, v137
    s_mov_b32 exec_lo, 0xffffffff
    s_mov_b32 exec_hi, 0x0
    buffer_store_dwordx3 v[132:134], v48, s[60:63], s76 offen
    s_mov_b64 exec, -1
    s_barrier
    s_mov_b32 exec_lo, 0x0
    s_mov_b32 exec_hi, 0xffffffff
    ds_read2st64_b32 v[132:133], v46 offset0:0 offset1:34
    ds_read2st64_b32 v[134:135], v46 offset0:68 offset1:102
    ds_read2st64_b32 v[136:137], v47 offset0:151 offset1:219
    s_mov_b64 exec, -1
    s_waitcnt lgkmcnt(0)
    v_cvt_pk_bf16_f32 v132, v132, v133
    v_cvt_pk_bf16_f32 v133, v134, v135
    v_cvt_pk_bf16_f32 v134, v136, v137
    s_mov_b32 exec_lo, 0x0
    s_mov_b32 exec_hi, 0xffffffff
    buffer_store_dwordx3 v[132:134], v48, s[60:63], s76 offen
    s_mov_b64 exec, -1
    s_endpgm
L_A_c1:
    s_nop 0
    ds_read_b128 v[216:219], v44 offset:464
    ds_read_b128 v[220:223], v44 offset:448
    ds_read_b128 v[224:227], v44 offset:400
    ds_read_b128 v[228:231], v44 offset:336
    ds_read_b128 v[232:235], v44 offset:272
    s_waitcnt lgkmcnt(4)
    v_mfma_f32_16x16x32_bf16 v[96:99], v[180:183], v[216:219], 0
    ds_read2_b32 v[52:53], v49 offset0:65 offset1:63
    v_mfma_f32_16x16x32_bf16 v[2:5], v[216:219], v[16:19], 0
    ds_read2_b32 v[54:55], v49 offset0:130 offset1:128
    v_mfma_f32_16x16x32_bf16 v[6:9], v[216:219], v[20:23], 0
    ds_read2_b32 v[56:57], v49 offset0:194 offset1:192
    v_mfma_f32_16x16x32_bf16 v[10:13], v[216:219], v[24:27], 0
    ds_read2_b32 v[58:59], v49 offset0:2 offset1:0
    v_mfma_f32_16x16x32_bf16 v[128:131], v[216:219], v[32:35], 0
    ds_read2_b32 v[60:61], v49 offset0:81 offset1:79
    ds_read_b128 v[236:239], v44 offset:208
    s_waitcnt lgkmcnt(9)
    v_mfma_f32_16x16x32_bf16 v[124:127], v[220:223], v[28:31], 0
    ds_read2_b32 v[62:63], v49 offset0:146 offset1:144
    v_mfma_f32_16x16x32_bf16 v[140:143], v[220:223], v[36:39], 0
    ds_read2_b32 v[64:65], v49 offset0:210 offset1:208
    ds_read_b128 v[216:219], v44 offset:144
    s_waitcnt lgkmcnt(11)
    v_mfma_f32_16x16x32_bf16 v[96:99], v[184:187], v[224:227], v[96:99]
    ds_read2_b32 v[66:67], v49 offset0:18 offset1:16
    ds_read_b128 v[220:223], v44 offset:80
    s_waitcnt lgkmcnt(12)
    v_mfma_f32_16x16x32_bf16 v[96:99], v[188:191], v[228:231], v[96:99]
    ds_read2_b32 v[68:69], v49 offset0:97 offset1:95
    ds_read_b128 v[224:227], v44 offset:16
    v_cvt_pk_bf16_f32 v144, v2, v3
    v_cvt_pk_bf16_f32 v145, v4, v5
    v_cvt_pk_bf16_f32 v146, v6, v7
    v_cvt_pk_bf16_f32 v147, v8, v9
    s_waitcnt lgkmcnt(13)
    v_mfma_f32_16x16x32_bf16 v[96:99], v[192:195], v[232:235], v[96:99]
    ds_read2_b32 v[70:71], v49 offset0:162 offset1:160
    ds_read_b128 v[228:231], v44 offset:976
    v_cvt_pk_bf16_f32 v240, v10, v11
    v_cvt_pk_bf16_f32 v241, v12, v13
    v_cvt_pk_bf16_f32 v242, v124, v125
    v_cvt_pk_bf16_f32 v243, v126, v127
    s_waitcnt lgkmcnt(9)
    v_mfma_f32_16x16x32_bf16 v[96:99], v[196:199], v[236:239], v[96:99]
    ds_read2_b32 v[72:73], v49 offset0:226 offset1:224
    ds_read_b128 v[232:235], v44 offset:960
    v_cvt_pk_bf16_f32 v244, v128, v129
    v_cvt_pk_bf16_f32 v245, v130, v131
    v_cvt_pk_bf16_f32 v246, v140, v141
    v_cvt_pk_bf16_f32 v247, v142, v143
    s_waitcnt lgkmcnt(8)
    v_mfma_f32_16x16x32_bf16 v[96:99], v[200:203], v[216:219], v[96:99]
    ds_read2_b32 v[74:75], v49 offset0:34 offset1:32
    ds_read_b128 v[236:239], v44 offset:912
    s_waitcnt lgkmcnt(1)
    v_mfma_f32_16x16x32_bf16 v[104:107], v[144:147], v[60:63], 0
    ds_read2_b32 v[76:77], v50 offset0:2 offset1:0
    v_mfma_f32_16x16x32_bf16 v[96:99], v[204:207], v[220:223], v[96:99]
    ds_read2_b32 v[78:79], v50 offset0:82 offset1:80
    ds_read_b128 v[216:219], v44 offset:848
    v_mfma_f32_16x16x32_bf16 v[104:107], v[240:243], v[64:67], v[104:107]
    ds_read2_b32 v[80:81], v50 offset0:18 offset1:16
    v_mfma_f32_16x16x32_bf16 v[96:99], v[208:211], v[224:227], v[96:99]
    ds_read2_b32 v[82:83], v50 offset0:98 offset1:96
    ds_read_b128 v[220:223], v44 offset:784
    ds_read2_b32 v[84:85], v50 offset0:34 offset1:32
    ds_read2_b32 v[86:87], v50 offset0:114 offset1:112
    ds_read2_b32 v[88:89], v50 offset0:50 offset1:48
    ds_read2_b32 v[90:91], v50 offset0:130 offset1:128
    s_waitcnt lgkmcnt(0)
    v_mfma_f32_16x16x32_bf16 v[112:115], v[244:247], v[80:83], 0
    v_mfma_f32_16x16x32_bf16 v[120:123], v[244:247], v[88:91], 0
    v_mfma_f32_16x16x32_bf16 v[96:99], v[148:151], v[228:231], v[96:99]
    v_mfma_f32_16x16x32_bf16 v[2:5], v[228:231], v[16:19], 0
    v_mfma_f32_16x16x32_bf16 v[6:9], v[228:231], v[20:23], 0
    v_mfma_f32_16x16x32_bf16 v[10:13], v[228:231], v[24:27], 0
    v_mfma_f32_16x16x32_bf16 v[128:131], v[228:231], v[32:35], 0
    v_mfma_f32_16x16x32_bf16 v[104:107], v[212:215], v[228:231], v[104:107]
    v_mfma_f32_16x16x32_bf16 v[112:115], v[40:43], v[228:231], v[112:115]
    ds_read_b128 v[224:227], v44 offset:720
    v_mfma_f32_16x16x32_bf16 v[124:127], v[232:235], v[28:31], 0
    v_mfma_f32_16x16x32_bf16 v[140:143], v[232:235], v[36:39], 0
    ds_read_b128 v[228:231], v44 offset:656
    v_mfma_f32_16x16x32_bf16 v[96:99], v[152:155], v[236:239], v[96:99]
    ds_read_b128 v[232:235], v44 offset:592
    v_mfma_f32_16x16x32_bf16 v[96:99], v[156:159], v[216:219], v[96:99]
    ds_read_b128 v[236:239], v44 offset:528
    v_cvt_pk_bf16_f32 v144, v2, v3
    v_cvt_pk_bf16_f32 v145, v4, v5
    v_cvt_pk_bf16_f32 v146, v6, v7
    v_cvt_pk_bf16_f32 v147, v8, v9
    v_mfma_f32_16x16x32_bf16 v[96:99], v[160:163], v[220:223], v[96:99]
    ds_read_b128 v[216:219], v44 offset:1488
    v_cvt_pk_bf16_f32 v240, v10, v11
    v_cvt_pk_bf16_f32 v241, v12, v13
    v_cvt_pk_bf16_f32 v242, v124, v125
    v_cvt_pk_bf16_f32 v243, v126, v127
    s_waitcnt lgkmcnt(4)
    v_mfma_f32_16x16x32_bf16 v[96:99], v[164:167], v[224:227], v[96:99]
    ds_read_b128 v[220:223], v44 offset:1472
    v_cvt_pk_bf16_f32 v244, v128, v129
    v_cvt_pk_bf16_f32 v245, v130, v131
    v_cvt_pk_bf16_f32 v246, v140, v141
    v_cvt_pk_bf16_f32 v247, v142, v143
    v_mfma_f32_16x16x32_bf16 v[104:107], v[144:147], v[52:55], v[104:107]
    v_mfma_f32_16x16x32_bf16 v[112:115], v[144:147], v[68:71], v[112:115]
    s_waitcnt lgkmcnt(4)
    v_mfma_f32_16x16x32_bf16 v[96:99], v[168:171], v[228:231], v[96:99]
    ds_read_b128 v[224:227], v44 offset:1424
    v_mfma_f32_16x16x32_bf16 v[104:107], v[240:243], v[56:59], v[104:107]
    v_mfma_f32_16x16x32_bf16 v[112:115], v[240:243], v[72:75], v[112:115]
    s_waitcnt lgkmcnt(4)
    v_mfma_f32_16x16x32_bf16 v[96:99], v[172:175], v[232:235], v[96:99]
    ds_read_b128 v[228:231], v44 offset:1360
    v_mfma_f32_16x16x32_bf16 v[112:115], v[244:247], v[76:79], v[112:115]
    v_mfma_f32_16x16x32_bf16 v[120:123], v[244:247], v[84:87], v[120:123]
    s_waitcnt lgkmcnt(4)
    v_mfma_f32_16x16x32_bf16 v[96:99], v[176:179], v[236:239], v[96:99]
    ds_read_b128 v[232:235], v44 offset:1296
    s_waitcnt lgkmcnt(4)
    v_mfma_f32_16x16x32_bf16 v[104:107], v[180:183], v[216:219], v[104:107]
    v_mfma_f32_16x16x32_bf16 v[2:5], v[216:219], v[16:19], 0
    v_mfma_f32_16x16x32_bf16 v[6:9], v[216:219], v[20:23], 0
    v_mfma_f32_16x16x32_bf16 v[10:13], v[216:219], v[24:27], 0
    v_mfma_f32_16x16x32_bf16 v[128:131], v[216:219], v[32:35], 0
    ds_read_b128 v[236:239], v44 offset:1232
    s_waitcnt lgkmcnt(4)
    v_mfma_f32_16x16x32_bf16 v[124:127], v[220:223], v[28:31], 0
    v_mfma_f32_16x16x32_bf16 v[140:143], v[220:223], v[36:39], 0
    ds_read_b128 v[216:219], v44 offset:1168
    s_waitcnt lgkmcnt(4)
    v_mfma_f32_16x16x32_bf16 v[104:107], v[184:187], v[224:227], v[104:107]
    ds_read_b128 v[220:223], v44 offset:1104
    ds_write_b128 v45, v[96:99] offset:0
    s_waitcnt lgkmcnt(5)
    v_mfma_f32_16x16x32_bf16 v[104:107], v[188:191], v[228:231], v[104:107]
    ds_read_b128 v[224:227], v44 offset:1040
    v_cvt_pk_bf16_f32 v144, v2, v3
    v_cvt_pk_bf16_f32 v145, v4, v5
    v_cvt_pk_bf16_f32 v146, v6, v7
    v_cvt_pk_bf16_f32 v147, v8, v9
    s_waitcnt lgkmcnt(5)
    v_mfma_f32_16x16x32_bf16 v[104:107], v[192:195], v[232:235], v[104:107]
    ds_read_b128 v[228:231], v44 offset:2000
    v_cvt_pk_bf16_f32 v240, v10, v11
    v_cvt_pk_bf16_f32 v241, v12, v13
    v_cvt_pk_bf16_f32 v242, v124, v125
    v_cvt_pk_bf16_f32 v243, v126, v127
    s_waitcnt lgkmcnt(5)
    v_mfma_f32_16x16x32_bf16 v[104:107], v[196:199], v[236:239], v[104:107]
    ds_read_b128 v[232:235], v44 offset:1984
    v_cvt_pk_bf16_f32 v244, v128, v129
    v_cvt_pk_bf16_f32 v245, v130, v131
    v_cvt_pk_bf16_f32 v246, v140, v141
    v_cvt_pk_bf16_f32 v247, v142, v143
    v_mfma_f32_16x16x32_bf16 v[112:115], v[144:147], v[60:63], v[112:115]
    s_waitcnt lgkmcnt(5)
    v_mfma_f32_16x16x32_bf16 v[104:107], v[200:203], v[216:219], v[104:107]
    ds_read_b128 v[236:239], v44 offset:1936
    v_mfma_f32_16x16x32_bf16 v[112:115], v[240:243], v[64:67], v[112:115]
    s_waitcnt lgkmcnt(5)
    v_mfma_f32_16x16x32_bf16 v[104:107], v[204:207], v[220:223], v[104:107]
    ds_read_b128 v[216:219], v44 offset:1872
    v_mfma_f32_16x16x32_bf16 v[120:123], v[244:247], v[80:83], v[120:123]
    s_waitcnt lgkmcnt(4)
    v_mfma_f32_16x16x32_bf16 v[104:107], v[208:211], v[224:227], v[104:107]
    ds_read_b128 v[220:223], v44 offset:1808
    s_waitcnt lgkmcnt(4)
    v_mfma_f32_16x16x32_bf16 v[104:107], v[148:151], v[228:231], v[104:107]
    v_mfma_f32_16x16x32_bf16 v[2:5], v[228:231], v[16:19], 0
    v_mfma_f32_16x16x32_bf16 v[6:9], v[228:231], v[20:23], 0
    v_mfma_f32_16x16x32_bf16 v[10:13], v[228:231], v[24:27], 0
    v_mfma_f32_16x16x32_bf16 v[128:131], v[228:231], v[32:35], 0
    v_mfma_f32_16x16x32_bf16 v[112:115], v[212:215], v[228:231], v[112:115]
    v_mfma_f32_16x16x32_bf16 v[120:123], v[40:43], v[228:231], v[120:123]
    ds_read_b128 v[224:227], v44 offset:1744
    s_waitcnt lgkmcnt(4)
    v_mfma_f32_16x16x32_bf16 v[124:127], v[232:235], v[28:31], 0
    v_mfma_f32_16x16x32_bf16 v[140:143], v[232:235], v[36:39], 0
    ds_read_b128 v[228:231], v44 offset:1680
    s_waitcnt lgkmcnt(4)
    v_mfma_f32_16x16x32_bf16 v[104:107], v[152:155], v[236:239], v[104:107]
    ds_read_b128 v[232:235], v44 offset:1616
    s_barrier
    ds_read2st64_b32 v[132:133], v46 offset0:0 offset1:34
    ds_read2st64_b32 v[134:135], v46 offset0:68 offset1:102
    ds_read2st64_b32 v[136:137], v47 offset0:136 offset1:204
    s_waitcnt lgkmcnt(7)
    v_mfma_f32_16x16x32_bf16 v[104:107], v[156:159], v[216:219], v[104:107]
    ds_read_b128 v[236:239], v44 offset:1552
    v_cvt_pk_bf16_f32 v144, v2, v3
    v_cvt_pk_bf16_f32 v145, v4, v5
    v_cvt_pk_bf16_f32 v146, v6, v7
    v_cvt_pk_bf16_f32 v147, v8, v9
    s_waitcnt lgkmcnt(7)
    v_mfma_f32_16x16x32_bf16 v[104:107], v[160:163], v[220:223], v[104:107]
    ds_read_b128 v[216:219], v44 offset:2512
    v_cvt_pk_bf16_f32 v240, v10, v11
    v_cvt_pk_bf16_f32 v241, v12, v13
    v_cvt_pk_bf16_f32 v242, v124, v125
    v_cvt_pk_bf16_f32 v243, v126, v127
    s_waitcnt lgkmcnt(2)
    v_cvt_pk_bf16_f32 v132, v132, v133
    v_cvt_pk_bf16_f32 v133, v134, v135
    v_cvt_pk_bf16_f32 v134, v136, v137
    buffer_store_dwordx3 v[132:134], v48, s[60:63], s76 offen
    s_add_u32 s76, s76, s77
    v_mfma_f32_16x16x32_bf16 v[104:107], v[164:167], v[224:227], v[104:107]
    ds_read_b128 v[220:223], v44 offset:2496
    v_cvt_pk_bf16_f32 v244, v128, v129
    v_cvt_pk_bf16_f32 v245, v130, v131
    v_cvt_pk_bf16_f32 v246, v140, v141
    v_cvt_pk_bf16_f32 v247, v142, v143
    v_mfma_f32_16x16x32_bf16 v[112:115], v[144:147], v[52:55], v[112:115]
    v_mfma_f32_16x16x32_bf16 v[120:123], v[144:147], v[68:71], v[120:123]
    v_mfma_f32_16x16x32_bf16 v[104:107], v[168:171], v[228:231], v[104:107]
    ds_read_b128 v[224:227], v44 offset:2448
    v_mfma_f32_16x16x32_bf16 v[112:115], v[240:243], v[56:59], v[112:115]
    v_mfma_f32_16x16x32_bf16 v[120:123], v[240:243], v[72:75], v[120:123]
    v_mfma_f32_16x16x32_bf16 v[104:107], v[172:175], v[232:235], v[104:107]
    ds_read_b128 v[228:231], v44 offset:2384
    v_mfma_f32_16x16x32_bf16 v[120:123], v[244:247], v[76:79], v[120:123]
    s_waitcnt lgkmcnt(4)
    v_mfma_f32_16x16x32_bf16 v[104:107], v[176:179], v[236:239], v[104:107]
    ds_read_b128 v[232:235], v44 offset:2320
    s_waitcnt lgkmcnt(4)
    v_mfma_f32_16x16x32_bf16 v[112:115], v[180:183], v[216:219], v[112:115]
    v_mfma_f32_16x16x32_bf16 v[2:5], v[216:219], v[16:19], 0
    v_mfma_f32_16x16x32_bf16 v[6:9], v[216:219], v[20:23], 0
    v_mfma_f32_16x16x32_bf16 v[10:13], v[216:219], v[24:27], 0
    ds_read_b128 v[236:239], v44 offset:2256
    s_waitcnt lgkmcnt(4)
    v_mfma_f32_16x16x32_bf16 v[124:127], v[220:223], v[28:31], 0
    ds_read_b128 v[216:219], v44 offset:2192
    s_waitcnt lgkmcnt(4)
    v_mfma_f32_16x16x32_bf16 v[112:115], v[184:187], v[224:227], v[112:115]
    ds_read_b128 v[220:223], v44 offset:2128
    ds_write_b128 v45, v[104:107] offset:1280
    s_waitcnt lgkmcnt(5)
    v_mfma_f32_16x16x32_bf16 v[112:115], v[188:191], v[228:231], v[112:115]
    ds_read_b128 v[224:227], v44 offset:2064
    v_cvt_pk_bf16_f32 v144, v2, v3
    v_cvt_pk_bf16_f32 v145, v4, v5
    v_cvt_pk_bf16_f32 v146, v6, v7
    v_cvt_pk_bf16_f32 v147, v8, v9
    s_waitcnt lgkmcnt(5)
    v_mfma_f32_16x16x32_bf16 v[112:115], v[192:195], v[232:235], v[112:115]
    ds_read_b128 v[228:231], v44 offset:3024
    v_cvt_pk_bf16_f32 v240, v10, v11
    v_cvt_pk_bf16_f32 v241, v12, v13
    v_cvt_pk_bf16_f32 v242, v124, v125
    v_cvt_pk_bf16_f32 v243, v126, v127
    s_waitcnt lgkmcnt(2)
    s_barrier
    ds_read2st64_b32 v[132:133], v46 offset0:10 offset1:44
    ds_read2st64_b32 v[134:135], v46 offset0:78 offset1:112
    ds_read2st64_b32 v[136:137], v47 offset0:141 offset1:209
    v_mfma_f32_16x16x32_bf16 v[112:115], v[196:199], v[236:239], v[112:115]
    ds_read_b128 v[232:235], v44 offset:3008
    v_mfma_f32_16x16x32_bf16 v[120:123], v[144:147], v[60:63], v[120:123]
    v_mfma_f32_16x16x32_bf16 v[112:115], v[200:203], v[216:219], v[112:115]
    ds_read_b128 v[236:239], v44 offset:2960
    v_mfma_f32_16x16x32_bf16 v[120:123], v[240:243], v[64:67], v[120:123]
    s_waitcnt lgkmcnt(2)
    v_cvt_pk_bf16_f32 v132, v132, v133
    v_cvt_pk_bf16_f32 v133, v134, v135
    v_cvt_pk_bf16_f32 v134, v136, v137
    buffer_store_dwordx3 v[132:134], v48, s[60:63], s76 offen
    s_add_u32 s76, s76, s77
    v_mfma_f32_16x16x32_bf16 v[112:115], v[204:207], v[220:223], v[112:115]
    ds_read_b128 v[216:219], v44 offset:2896
    v_mfma_f32_16x16x32_bf16 v[112:115], v[208:211], v[224:227], v[112:115]
    ds_read_b128 v[220:223], v44 offset:2832
    v_mfma_f32_16x16x32_bf16 v[112:115], v[148:151], v[228:231], v[112:115]
    v_mfma_f32_16x16x32_bf16 v[2:5], v[228:231], v[16:19], 0
    v_mfma_f32_16x16x32_bf16 v[6:9], v[228:231], v[20:23], 0
    v_mfma_f32_16x16x32_bf16 v[10:13], v[228:231], v[24:27], 0
    v_mfma_f32_16x16x32_bf16 v[120:123], v[212:215], v[228:231], v[120:123]
    ds_read_b128 v[224:227], v44 offset:2768
    s_waitcnt lgkmcnt(4)
    v_mfma_f32_16x16x32_bf16 v[124:127], v[232:235], v[28:31], 0
    ds_read_b128 v[228:231], v44 offset:2704
    s_waitcnt lgkmcnt(4)
    v_mfma_f32_16x16x32_bf16 v[112:115], v[152:155], v[236:239], v[112:115]
    ds_read_b128 v[232:235], v44 offset:2640
    s_waitcnt lgkmcnt(4)
    v_mfma_f32_16x16x32_bf16 v[112:115], v[156:159], v[216:219], v[112:115]
    ds_read_b128 v[236:239], v44 offset:2576
    v_cvt_pk_bf16_f32 v144, v2, v3
    v_cvt_pk_bf16_f32 v145, v4, v5
    v_cvt_pk_bf16_f32 v146, v6, v7
    v_cvt_pk_bf16_f32 v147, v8, v9
    s_waitcnt lgkmcnt(4)
    v_mfma_f32_16x16x32_bf16 v[112:115], v[160:163], v[220:223], v[112:115]
    ds_read_b128 v[216:219], v44 offset:3536
    v_cvt_pk_bf16_f32 v240, v10, v11
    v_cvt_pk_bf16_f32 v241, v12, v13
    v_cvt_pk_bf16_f32 v242, v124, v125
    v_cvt_pk_bf16_f32 v243, v126, v127
    s_waitcnt lgkmcnt(4)
    v_mfma_f32_16x16x32_bf16 v[112:115], v[164:167], v[224:227], v[112:115]
    ds_read_b128 v[220:223], v44 offset:3472
    v_mfma_f32_16x16x32_bf16 v[120:123], v[144:147], v[52:55], v[120:123]
    s_waitcnt lgkmcnt(4)
    v_mfma_f32_16x16x32_bf16 v[112:115], v[168:171], v[228:231], v[112:115]
    ds_read_b128 v[224:227], v44 offset:3408
    v_mfma_f32_16x16x32_bf16 v[120:123], v[240:243], v[56:59], v[120:123]
    s_waitcnt lgkmcnt(4)
    v_mfma_f32_16x16x32_bf16 v[112:115], v[172:175], v[232:235], v[112:115]
    ds_read_b128 v[228:231], v44 offset:3344
    s_waitcnt lgkmcnt(4)
    v_mfma_f32_16x16x32_bf16 v[112:115], v[176:179], v[236:239], v[112:115]
    ds_read_b128 v[232:235], v44 offset:3280
    s_waitcnt lgkmcnt(4)
    v_mfma_f32_16x16x32_bf16 v[120:123], v[180:183], v[216:219], v[120:123]
    ds_read_b128 v[236:239], v44 offset:3216
    s_waitcnt lgkmcnt(4)
    v_mfma_f32_16x16x32_bf16 v[120:123], v[184:187], v[220:223], v[120:123]
    ds_read_b128 v[216:219], v44 offset:3152
    s_nop 0
    ds_write_b128 v45, v[112:115] offset:2560
    s_waitcnt lgkmcnt(5)
    v_mfma_f32_16x16x32_bf16 v[120:123], v[188:191], v[224:227], v[120:123]
    ds_read_b128 v[220:223], v44 offset:3088
    s_waitcnt lgkmcnt(5)
    v_mfma_f32_16x16x32_bf16 v[120:123], v[192:195], v[228:231], v[120:123]
    ds_read_b128 v[224:227], v44 offset:4048
    s_waitcnt lgkmcnt(2)
    s_barrier
    ds_read2st64_b32 v[132:133], v46 offset0:20 offset1:54
    ds_read2st64_b32 v[134:135], v46 offset0:88 offset1:122
    ds_read2st64_b32 v[136:137], v47 offset0:146 offset1:214
    v_mfma_f32_16x16x32_bf16 v[120:123], v[196:199], v[232:235], v[120:123]
    ds_read_b128 v[228:231], v44 offset:3984
    v_mfma_f32_16x16x32_bf16 v[120:123], v[200:203], v[236:239], v[120:123]
    ds_read_b128 v[232:235], v44 offset:3920
    s_waitcnt lgkmcnt(2)
    v_cvt_pk_bf16_f32 v132, v132, v133
    v_cvt_pk_bf16_f32 v133, v134, v135
    v_cvt_pk_bf16_f32 v134, v136, v137
    buffer_store_dwordx3 v[132:134], v48, s[60:63], s76 offen
    s_add_u32 s76, s76, s77
    v_mfma_f32_16x16x32_bf16 v[120:123], v[204:207], v[216:219], v[120:123]
    ds_read_b128 v[236:239], v44 offset:3856
    v_mfma_f32_16x16x32_bf16 v[120:123], v[208:211], v[220:223], v[120:123]
    ds_read_b128 v[216:219], v44 offset:3792
    v_mfma_f32_16x16x32_bf16 v[120:123], v[148:151], v[224:227], v[120:123]
    ds_read_b128 v[220:223], v44 offset:3728
    s_waitcnt lgkmcnt(4)
    v_mfma_f32_16x16x32_bf16 v[120:123], v[152:155], v[228:231], v[120:123]
    ds_read_b128 v[224:227], v44 offset:3664
    s_waitcnt lgkmcnt(4)
    v_mfma_f32_16x16x32_bf16 v[120:123], v[156:159], v[232:235], v[120:123]
    ds_read_b128 v[228:231], v44 offset:3600
    s_waitcnt lgkmcnt(4)
    v_mfma_f32_16x16x32_bf16 v[120:123], v[160:163], v[236:239], v[120:123]
    s_barrier
    s_mov_b32 exec_lo, 0xffffffff
    s_mov_b32 exec_hi, 0x0
    ds_read2st64_b32 v[132:133], v46 offset0:0 offset1:34
    ds_read2st64_b32 v[134:135], v46 offset0:68 offset1:102
    ds_read2st64_b32 v[136:137], v47 offset0:151 offset1:219
    s_mov_b64 exec, -1
    s_waitcnt lgkmcnt(6)
    v_mfma_f32_16x16x32_bf16 v[120:123], v[164:167], v[216:219], v[120:123]
    s_waitcnt lgkmcnt(5)
    v_mfma_f32_16x16x32_bf16 v[120:123], v[168:171], v[220:223], v[120:123]
    s_waitcnt lgkmcnt(0)
    v_cvt_pk_bf16_f32 v132, v132, v133
    v_cvt_pk_bf16_f32 v133, v134, v135
    v_cvt_pk_bf16_f32 v134, v136, v137
    s_mov_b32 exec_lo, 0xffffffff
    s_mov_b32 exec_hi, 0x0
    buffer_store_dwordx3 v[132:134], v48, s[60:63], s76 offen
    s_mov_b64 exec, -1
    v_mfma_f32_16x16x32_bf16 v[120:123], v[172:175], v[224:227], v[120:123]
    v_mfma_f32_16x16x32_bf16 v[120:123], v[176:179], v[228:231], v[120:123]
    s_nop 7
    ds_write_b128 v45, v[120:123] offset:3840
    s_waitcnt lgkmcnt(0)
    s_barrier
    s_mov_b32 exec_lo, 0x0
    s_mov_b32 exec_hi, 0xffffffff
    ds_read2st64_b32 v[132:133], v46 offset0:0 offset1:34
    ds_read2st64_b32 v[134:135], v46 offset0:68 offset1:102
    ds_read2st64_b32 v[136:137], v47 offset0:151 offset1:219
    s_mov_b64 exec, -1
    s_waitcnt lgkmcnt(0)
    v_cvt_pk_bf16_f32 v132, v132, v133
    v_cvt_pk_bf16_f32 v133, v134, v135
    v_cvt_pk_bf16_f32 v134, v136, v137
    s_mov_b32 exec_lo, 0x0
    s_mov_b32 exec_hi, 0xffffffff
    buffer_store_dwordx3 v[132:134], v48, s[60:63], s76 offen
    s_mov_b64 exec, -1
    s_endpgm
L_B1:
    s_cmp_eq_u32 s15, 0
    s_cselect_b32 s74, 1, 0
    s_cbranch_scc0 L_B_noedge
    s_mov_b64 exec, 1
    global_load_lds_dwordx4 v2, s[42:43] offset:2048
    s_mov_b64 exec, -1
L_B_noedge:
    s_mov_b32 s56, s50
    s_mov_b32 s57, s51
    s_mov_b32 s58, 2359296
    s_mov_b32 s59, 0x20000
    s_cmp_lg_u32 s6, 7
    s_cbranch_scc1 L_B_nocas
    s_memrealtime s[64:65]
    s_mul_i32 s3, s10, 24
    v_mov_b32 v2, s3
    v_mov_b32 v122, 0
    v_mov_b32 v123, 0
    s_waitcnt lgkmcnt(0)
    v_mov_b32 v120, s64
    v_mov_b32 v121, s65
    s_mov_b64 exec, 1
    global_atomic_cmpswap_x2 v[126:127], v2, v[120:123], s[48:49] sc0 sc1
    s_mov_b64 exec, -1
L_B_nocas:
    s_add_u32 s70, s50, 4194304
    s_addc_u32 s71, s51, 0
    s_lshl_b32 s3, s10, 9
    s_add_u32 s70, s70, s3
    s_addc_u32 s71, s71, 0
    s_cmp_lg_u32 s6, 4
    s_cbranch_scc1 L_B_nofl
    v_lshlrev_b32 v2, 3, v1
    global_load_dword v4, v2, s[70:71] sc1
L_B_nofl:
    v_lshrrev_b32 v19, 5, v1
    v_and_b32 v20, 31, v1
    v_lshlrev_b32_e64 v6, 9, v19
    v_lshl_add_u32 v6, v20, 2, v6
    s_add_u32 s3, s13, 640
    v_add_u32 v6, s3, v6
    s_lshr_b32 s3, s6, 1
    s_add_u32 s3, s3, 1
    v_and_b32 v7, 1, v1
    v_lshlrev_b32 v7, 1, v7
    v_sub_u32 v7, v7, v19
    v_add_u32 v7, s3, v7
    v_and_b32 v7, 3, v7
    v_lshrrev_b32 v20, 1, v20
    v_lshlrev_b32 v20, 14, v20
    v_lshl_add_u32 v7, v7, 4, v20
    s_lshl_b32 s3, s6, 7
    s_add_u32 s3, s3, s66
    v_add_u32_e64 v7, s3, v7
    s_mov_b32 s67, 0xffff0000
    s_mov_b32 s68, 0x05040100
    s_mov_b32 s69, 0x07060302
    s_getreg_b32 s64, hwreg(HW_REG_XCC_ID, 0, 4)
    v_mov_b32 v28, 0
    v_mov_b32 v29, 0
    v_mov_b32 v30, 0
    v_mov_b32 v31, 0
    v_lshlrev_b32 v19, 2, v0
    v_add_u32 v19, 107520, v19
    ds_write_b32 v19, v28
    v_lshrrev_b32 v19, 1, v1
    v_mul_u32_u24 v19, 4160, v19
    v_and_b32 v20, 1, v1
    v_lshl_add_u32 v19, v20, 4, v19
    v_add_u32 v19, s12, v19
    s_mul_i32 s3, s74, 255
    s_mov_b32 exec_hi, 0
    s_mov_b32 exec_lo, s3
    ds_write_b128 v19, v[28:31] offset:0
    s_mov_b64 exec, -1
    s_add_u32 s3, s12, 32
    v_lshl_add_u32 v12, v1, 2, s3
    s_add_u32 m0, s12, 0
    s_mov_b32 s73, 0
    s_waitcnt vmcnt(4)
    ds_read_b32 v32, v6 offset:0
    ds_read_b32 v33, v6 offset:128
    ds_read_b32 v34, v6 offset:256
    ds_read_b32 v35, v6 offset:384
    ds_read_b32 v36, v6 offset:512
    ds_read_b32 v37, v6 offset:640
    ds_read_b32 v38, v6 offset:768
    ds_read_b32 v39, v6 offset:2432
    ds_read_b32 v40, v6 offset:2560
    ds_read_b32 v41, v6 offset:2688
    ds_read_b32 v42, v6 offset:2816
    ds_read_b32 v43, v6 offset:1024
    ds_read_b32 v44, v6 offset:1152
    ds_read_b32 v45, v6 offset:1280
    ds_read_b32 v46, v6 offset:1408
    ds_read_b32 v47, v6 offset:1536
    ds_read_b32 v48, v6 offset:1664
    ds_read_b32 v49, v6 offset:1792
    ds_read_b32 v50, v6 offset:3456
    ds_read_b32 v51, v6 offset:3584
    ds_read_b32 v52, v6 offset:3712
    ds_read_b32 v53, v6 offset:3840
    s_waitcnt lgkmcnt(11)
    s_nop 0
    v_perm_b32 v54, v32, v33, s68
    v_perm_b32 v55, v33, v34, s68
    v_perm_b32 v56, v34, v35, s68
    v_perm_b32 v57, v35, v36, s68
    v_perm_b32 v58, v36, v37, s68
    v_perm_b32 v59, v37, v38, s68
    v_dot2_f32_bf16 v60, v56, v8, 0
    v_dot2_f32_bf16 v61, v57, v8, 0
    v_dot2_f32_bf16 v62, v58, v8, 0
    v_dot2_f32_bf16 v63, v59, v8, 0
    v_dot2_f32_bf16 v60, v54, v9, v60
    v_dot2_f32_bf16 v61, v55, v9, v61
    v_dot2_f32_bf16 v62, v56, v9, v62
    v_dot2_f32_bf16 v63, v57, v9, v63
    v_lshlrev_b32 v54, 16, v39
    v_lshlrev_b32 v55, 16, v40
    v_lshlrev_b32 v56, 16, v41
    v_lshlrev_b32 v57, 16, v42
    v_mul_f32 v60, v60, v54
    v_mul_f32 v61, v61, v55
    v_mul_f32 v62, v62, v56
    v_mul_f32 v63, v63, v57
    v_cvt_pk_bf16_f32 v64, v63, v62
    v_cvt_pk_bf16_f32 v65, v61, v60
    v_perm_b32 v54, v32, v33, s69
    v_perm_b32 v55, v33, v34, s69
    v_perm_b32 v56, v34, v35, s69
    v_perm_b32 v57, v35, v36, s69
    v_perm_b32 v58, v36, v37, s69
    v_perm_b32 v59, v37, v38, s69
    v_dot2_f32_bf16 v60, v56, v10, 0
    v_dot2_f32_bf16 v61, v57, v10, 0
    v_dot2_f32_bf16 v62, v58, v10, 0
    v_dot2_f32_bf16 v63, v59, v10, 0
    v_dot2_f32_bf16 v60, v54, v11, v60
    v_dot2_f32_bf16 v61, v55, v11, v61
    v_dot2_f32_bf16 v62, v56, v11, v62
    v_dot2_f32_bf16 v63, v57, v11, v63
    v_and_b32 v54, s67, v39
    v_and_b32 v55, s67, v40
    v_and_b32 v56, s67, v41
    v_and_b32 v57, s67, v42
    v_mul_f32 v60, v60, v54
    v_mul_f32 v61, v61, v55
    v_mul_f32 v62, v62, v56
    v_mul_f32 v63, v63, v57
    v_cvt_pk_bf16_f32 v66, v63, v62
    v_cvt_pk_bf16_f32 v67, v61, v60
    s_nop 0
    v_permlane32_swap_b32 v66, v64
    v_permlane32_swap_b32 v67, v65
    buffer_store_dwordx4 v[64:67], v7, s[56:59], 0 offen offset:0
    s_waitcnt lgkmcnt(0)
    v_perm_b32 v54, v43, v44, s68
    v_perm_b32 v55, v44, v45, s68
    v_perm_b32 v56, v45, v46, s68
    v_perm_b32 v57, v46, v47, s68
    v_perm_b32 v58, v47, v48, s68
    v_perm_b32 v59, v48, v49, s68
    v_dot2_f32_bf16 v60, v56, v8, 0
    v_dot2_f32_bf16 v61, v57, v8, 0
    v_dot2_f32_bf16 v62, v58, v8, 0
    v_dot2_f32_bf16 v63, v59, v8, 0
    v_dot2_f32_bf16 v60, v54, v9, v60
    v_dot2_f32_bf16 v61, v55, v9, v61
    v_dot2_f32_bf16 v62, v56, v9, v62
    v_dot2_f32_bf16 v63, v57, v9, v63
    v_lshlrev_b32 v54, 16, v50
    v_lshlrev_b32 v55, 16, v51
    v_lshlrev_b32 v56, 16, v52
    v_lshlrev_b32 v57, 16, v53
    v_mul_f32 v60, v60, v54
    v_mul_f32 v61, v61, v55
    v_mul_f32 v62, v62, v56
    v_mul_f32 v63, v63, v57
    v_cvt_pk_bf16_f32 v32, v63, v62
    v_cvt_pk_bf16_f32 v33, v61, v60
    v_perm_b32 v54, v43, v44, s69
    v_perm_b32 v55, v44, v45, s69
    v_perm_b32 v56, v45, v46, s69
    v_perm_b32 v57, v46, v47, s69
    v_perm_b32 v58, v47, v48, s69
    v_perm_b32 v59, v48, v49, s69
    v_dot2_f32_bf16 v60, v56, v10, 0
    v_dot2_f32_bf16 v61, v57, v10, 0
    v_dot2_f32_bf16 v62, v58, v10, 0
    v_dot2_f32_bf16 v63, v59, v10, 0
    v_dot2_f32_bf16 v60, v54, v11, v60
    v_dot2_f32_bf16 v61, v55, v11, v61
    v_dot2_f32_bf16 v62, v56, v11, v62
    v_dot2_f32_bf16 v63, v57, v11, v63
    v_and_b32 v54, s67, v50
    v_and_b32 v55, s67, v51
    v_and_b32 v56, s67, v52
    v_and_b32 v57, s67, v53
    v_mul_f32 v60, v60, v54
    v_mul_f32 v61, v61, v55
    v_mul_f32 v62, v62, v56
    v_mul_f32 v63, v63, v57
    v_cvt_pk_bf16_f32 v34, v63, v62
    v_cvt_pk_bf16_f32 v35, v61, v60
    s_nop 0
    v_permlane32_swap_b32 v34, v32
    v_permlane32_swap_b32 v35, v33
    buffer_store_dwordx4 v[32:35], v7, s[56:59], 0 offen offset:64
    s_waitcnt vmcnt(3)
    s_cmp_lg_u32 s15, 0
    s_cbranch_scc1 L_B_havek
    s_waitcnt vmcnt(2)
L_B_havek:
    s_nop 0
    ds_read2_b32 v[68:69], v12 offset0:0 offset1:1
    ds_read2_b32 v[70:71], v12 offset0:64 offset1:65
    ds_read2_b32 v[72:73], v12 offset0:128 offset1:129
    ds_read2_b32 v[74:75], v12 offset0:192 offset1:193
    v_add_u32 v12, 1024, v12
    ds_read2_b32 v[76:77], v12 offset0:0 offset1:1
    ds_read2_b32 v[78:79], v12 offset0:64 offset1:65
    ds_read2_b32 v[80:81], v12 offset0:128 offset1:129
    ds_read2_b32 v[82:83], v12 offset0:192 offset1:193
    v_lshlrev_b32 v5, 16, v5
    v_mov_b32 v20, s12
    s_mov_b32 s3, 0xffff
    s_waitcnt lgkmcnt(7)
    v_lshlrev_b32 v19, 16, v68
    v_add_f32 v19, v19, v5
    v_cvt_pk_bf16_f32 v19, v19, v19
    s_mov_b32 exec_hi, 0
    s_mov_b32 exec_lo, s74
    v_bfi_b32 v68, s3, v19, v68
    v_lshlrev_b32 v19, 16, v19
    ds_write_b32 v20, v68 offset:32
    ds_write_b32 v20, v19 offset:4188
    ds_write_b32 v20, v19 offset:12504
    s_mov_b64 exec, -1
    ds_write_addtid_b32 v68 offset:8348
    v_alignbit_b32 v69, v69, v68, 16
    ds_write_addtid_b32 v69 offset:4192
    ds_write_addtid_b32 v69 offset:12508
    s_waitcnt lgkmcnt(12)
    ds_write_addtid_b32 v70 offset:8604
    v_alignbit_b32 v71, v71, v70, 16
    ds_write_addtid_b32 v71 offset:4448
    ds_write_addtid_b32 v71 offset:12764
    s_waitcnt lgkmcnt(14)
    ds_write_addtid_b32 v72 offset:8860
    v_alignbit_b32 v73, v73, v72, 16
    ds_write_addtid_b32 v73 offset:4704
    ds_write_addtid_b32 v73 offset:13020
    s_waitcnt lgkmcnt(15)
    ds_write_addtid_b32 v74 offset:9116
    v_alignbit_b32 v75, v75, v74, 16
    ds_write_addtid_b32 v75 offset:4960
    ds_write_addtid_b32 v75 offset:13276
    ds_write_addtid_b32 v76 offset:9372
    v_alignbit_b32 v77, v77, v76, 16
    ds_write_addtid_b32 v77 offset:5216
    ds_write_addtid_b32 v77 offset:13532
    s_waitcnt lgkmcnt(15)
    s_nop 0
    ds_write_addtid_b32 v78 offset:9628
    v_alignbit_b32 v79, v79, v78, 16
    ds_write_addtid_b32 v79 offset:5472
    ds_write_addtid_b32 v79 offset:13788
    ds_write_addtid_b32 v80 offset:9884
    v_alignbit_b32 v81, v81, v80, 16
    ds_write_addtid_b32 v81 offset:5728
    ds_write_addtid_b32 v81 offset:14044
    ds_write_addtid_b32 v82 offset:10140
    v_alignbit_b32 v83, v83, v82, 16
    ds_write_addtid_b32 v83 offset:5984
    ds_write_addtid_b32 v83 offset:14300
    v_and_b32 v19, 15, v1
    v_add_u32 v19, 1, v19
    v_and_b32 v20, 3, v19
    v_mul_u32_u24 v13, 4160, v20
    v_lshrrev_b32 v19, 2, v19
    v_lshl_add_u32 v13, v19, 3, v13
    v_lshrrev_b32_e64 v19, 4, v1
    v_lshl_add_u32 v13, v19, 4, v13
    s_mul_i32 s75, s14, 16640
    s_lshl_b32 s3, s15, 8
    s_add_u32 s3, s3, s75
    s_add_u32 s3, s3, 0
    v_add_u32 v13, s3, v13
    s_lshl_b32 s72, s9, 14
    s_lshl_b32 s3, s6, 11
    s_add_u32 s65, s3, 109568
    s_add_u32 s3, s3, s72
    v_lshl_add_u32 v14, v1, 4, s3
    s_mov_b32 m0, s65
    v_mov_b32 v19, 125952
    v_mov_b32 v20, 1
    s_waitcnt vmcnt(0)
    s_cmp_lg_u32 s6, 7
    s_cbranch_scc1 L_B_notag
    v_cmp_eq_u64 vcc, 0, v[126:127]
    s_nop 1
    v_cndmask_b32 v126, v126, v120, vcc
    v_cndmask_b32 v127, v127, v121, vcc
    s_mov_b64 exec, 1
    ds_write_b64 v19, v[126:127]
    s_mov_b64 exec, -1
L_B_notag:
    s_mov_b64 exec, 1
    ds_add_rtn_u32 v20, v19, v20 offset:8
    s_mov_b64 exec, -1
    ds_read_b64 v[126:127], v19
    s_waitcnt lgkmcnt(1)
    v_readfirstlane_b32 s76, v20
    s_nop 0
    s_cmp_eq_u32 s76, 7
    s_cbranch_scc1 L_B_last
    s_waitcnt lgkmcnt(0)
    s_barrier
    ds_read_b64 v[128:129], v13 offset:0
    s_lshl_b32 s3, s6, 8
    s_add_u32 s3, s3, s72
    ds_read_b64 v[130:131], v13 offset:8
    v_lshl_add_u32 v17, v1, 2, s3
    s_lshl_b32 s3, s11, 3
    ds_read_b64 v[132:133], v13 offset:64
    s_add_u32 s3, s3, s6
    s_lshl_b32 s3, s3, 3
    ds_read_b64 v[134:135], v13 offset:72
    v_lshrrev_b32 v19, 3, v1
    v_add_u32 v19, s3, v19
    ds_read_b64 v[136:137], v13 offset:128
    v_and_b32 v20, 7, v1
    s_lshl_b32 s3, s10, 7
    ds_read_b64 v[138:139], v13 offset:136
    v_lshl_add_u32 v20, v20, 4, s3
    v_mul_u32_u24 v18, 2304, v19
    ds_read_b64 v[140:141], v13 offset:192
    v_add_u32 v18, v18, v20
    v_and_b32 v19, 15, v1
    ds_read_b64 v[142:143], v13 offset:200
    v_lshlrev_b32 v19, 1, v19
    v_lshrrev_b32 v20, 4, v1
    ds_read_b64 v[144:145], v13 offset:512
    v_sub_u32 v19, v19, v20
    s_lshl_b32 s3, s15, 4
    ds_read_b64 v[146:147], v13 offset:520
    s_sub_u32 s3, 33, s3
    v_add_u32 v19, s3, v19
    ds_read_b64 v[148:149], v13 offset:576
    s_mov_b32 s3, 107520
    v_lshrrev_b32 v20, 2, v19
    ds_read_b64 v[150:151], v13 offset:584
    v_add_u32 v20, s14, v20
    v_and_b32_e64 v20, 3, v20
    ds_read_b64 v[152:153], v13 offset:640
    v_lshl_add_u32 v20, v20, 4, s3
    v_lshl_add_u32 v22, v19, 6, v20
    ds_read_b64 v[154:155], v13 offset:648
    v_subrev_u32 v19, 4, v19
    v_lshrrev_b32 v20, 2, v19
    ds_read_b64 v[156:157], v13 offset:704
    v_add_u32 v20, s14, v20
    v_and_b32 v20, 3, v20
    ds_read_b64 v[158:159], v13 offset:712
    v_lshl_add_u32 v20, v20, 4, s3
    v_lshl_add_u32 v23, v19, 6, v20
    ds_read_b64 v[160:161], v13 offset:1024
    v_subrev_u32 v19, 4, v19
    v_lshrrev_b32 v20, 2, v19
    ds_read_b64 v[162:163], v13 offset:1032
    v_add_u32 v20, s14, v20
    v_and_b32 v20, 3, v20
    ds_read_b64 v[164:165], v13 offset:1088
    v_lshl_add_u32 v20, v20, 4, s3
    v_lshl_add_u32 v24, v19, 6, v20
    ds_read_b64 v[166:167], v13 offset:1096
    v_subrev_u32 v19, 4, v19
    v_lshrrev_b32 v20, 2, v19
    ds_read_b64 v[168:169], v13 offset:1152
    v_add_u32 v20, s14, v20
    v_and_b32 v20, 3, v20
    ds_read_b64 v[170:171], v13 offset:1160
    v_lshl_add_u32 v20, v20, 4, s3
    v_lshl_add_u32 v25, v19, 6, v20
    ds_read_b64 v[172:173], v13 offset:1216
    s_mul_i32 s3, s15, 5376
    s_mul_i32 s75, s14, 1280
    ds_read_b64 v[174:175], v13 offset:1224
    s_add_u32 s3, s3, s75
    s_lshr_b32 s75, s14, 1
    ds_read_b64 v[176:177], v13 offset:1536
    s_lshl_b32 s75, s75, 6
    s_add_u32 s3, s3, s75
    ds_read_b64 v[178:179], v13 offset:1544
    s_add_u32 s3, s3, 66560
    v_and_b32_e64 v19, 15, v1
    ds_read_b64 v[180:181], v13 offset:1600
    v_mul_u32_u24 v15, 80, v19
    v_lshrrev_b32_e64 v20, 4, v1
    ds_read_b64 v[182:183], v13 offset:1608
    v_lshl_add_u32 v15, v20, 4, v15
    v_add_u32_e64 v15, s3, v15
    ds_read_b64 v[184:185], v13 offset:1664
    s_mul_i32 s3, s6, 160
    s_add_u32 s3, s3, 66560
    ds_read_b64 v[186:187], v13 offset:1672
    v_lshrrev_b32_e64 v19, 5, v1
    v_mul_u32_u24 v16, 80, v19
    ds_read_b64 v[188:189], v13 offset:1728
    v_bfe_u32 v19, v1, 1, 4
    v_lshl_add_u32 v16, v19, 2, v16
    ds_read_b64 v[190:191], v13 offset:1736
    v_and_b32_e64 v19, 1, v1
    v_mul_u32_u24 v19, 2624, v19
    ds_read_b64 v[192:193], v13 offset:2048
    v_add3_u32 v16, v16, v19, s3
    ds_read_b64 v[194:195], v13 offset:2056
    ds_read_b64 v[196:197], v13 offset:2112
    ds_read_b64 v[198:199], v13 offset:2120
    ds_read_b64 v[200:201], v13 offset:2176
    ds_read_b64 v[202:203], v13 offset:2184
    ds_read_b64 v[204:205], v13 offset:2240
    ds_read_b64 v[206:207], v13 offset:2248
    ds_read_b64 v[208:209], v13 offset:2560
    ds_read_b64 v[210:211], v13 offset:2568
    ds_read_b64 v[212:213], v13 offset:2624
    ds_read_b64 v[214:215], v13 offset:2632
    ds_read_b64 v[216:217], v13 offset:2688
    ds_read_b64 v[218:219], v13 offset:2696
    ds_read_b64 v[220:221], v13 offset:2752
    ds_read_b64 v[222:223], v13 offset:2760
    ds_read_b64 v[224:225], v13 offset:3072
    ds_read_b64 v[226:227], v13 offset:3080
    ds_read_b64 v[228:229], v13 offset:3136
    ds_read_b64 v[230:231], v13 offset:3144
    ds_read_b64 v[232:233], v13 offset:3200
    ds_read_b64 v[234:235], v13 offset:3208
    ds_read_b64 v[236:237], v13 offset:3264
    ds_read_b64 v[238:239], v13 offset:3272
    ds_read_b64 v[240:241], v13 offset:3584
    ds_read_b64 v[242:243], v13 offset:3592
    ds_read_b64 v[244:245], v13 offset:3648
    ds_read_b64 v[246:247], v13 offset:3656
    ds_read_b64 v[248:249], v13 offset:3712
    ds_read_b64 v[250:251], v13 offset:3720
    ds_read_b64 v[252:253], v13 offset:3776
    ds_read_b64 v[254:255], v13 offset:3784
    s_branch L_B_join
L_B_last:
    v_lshlrev_b32 v2, 3, v1
    v_mov_b32 v3, s64
    v_cmp_gt_u32 vcc, 16, v1
    s_nop 1
    v_cndmask_b32 v3, 15, v3, vcc
    s_waitcnt lgkmcnt(0)
    v_and_b32 v126, -16, v126
    v_or_b32 v126, v3, v126
    s_lshl_b64 exec, 1, s11
    global_store_dwordx2 v2, v[126:127], s[70:71] offset:0
    s_mov_b64 exec, -1
    s_barrier
    s_lshl_b32 s3, s6, 8
    s_add_u32 s3, s3, s72
    v_lshl_add_u32 v17, v1, 2, s3
    s_lshl_b32 s3, s11, 3
    s_add_u32 s3, s3, s6
    s_lshl_b32 s3, s3, 3
    v_lshrrev_b32 v19, 3, v1
    v_add_u32 v19, s3, v19
    v_and_b32_e64 v20, 7, v1
    s_lshl_b32 s3, s10, 7
    v_lshl_add_u32 v20, v20, 4, s3
    v_mul_u32_u24 v18, 2304, v19
    v_add_u32 v18, v18, v20
    v_and_b32 v19, 15, v1
    v_lshlrev_b32 v19, 1, v19
    v_lshrrev_b32 v20, 4, v1
    v_sub_u32 v19, v19, v20
    s_lshl_b32 s3, s15, 4
    s_sub_u32 s3, 33, s3
    v_add_u32 v19, s3, v19
    s_mov_b32 s3, 107520
    v_lshrrev_b32 v20, 2, v19
    v_add_u32 v20, s14, v20
    v_and_b32_e64 v20, 3, v20
    v_lshl_add_u32 v20, v20, 4, s3
    v_lshl_add_u32 v22, v19, 6, v20
    v_subrev_u32 v19, 4, v19
    v_lshrrev_b32 v20, 2, v19
    v_add_u32 v20, s14, v20
    v_and_b32 v20, 3, v20
    v_lshl_add_u32 v20, v20, 4, s3
    v_lshl_add_u32 v23, v19, 6, v20
    v_subrev_u32 v19, 4, v19
    v_lshrrev_b32 v20, 2, v19
    v_add_u32 v20, s14, v20
    v_and_b32 v20, 3, v20
    v_lshl_add_u32 v20, v20, 4, s3
    v_lshl_add_u32 v24, v19, 6, v20
    v_subrev_u32 v19, 4, v19
    v_lshrrev_b32 v20, 2, v19
    v_add_u32 v20, s14, v20
    v_and_b32 v20, 3, v20
    v_lshl_add_u32 v20, v20, 4, s3
    v_lshl_add_u32 v25, v19, 6, v20
    s_mul_i32 s3, s15, 5376
    s_mul_i32 s75, s14, 1280
    s_add_u32 s3, s3, s75
    s_lshr_b32 s75, s14, 1
    s_lshl_b32 s75, s75, 6
    s_add_u32 s3, s3, s75
    s_add_u32 s3, s3, 66560
    v_and_b32 v19, 15, v1
    v_mul_u32_u24 v15, 80, v19
    v_lshrrev_b32 v20, 4, v1
    v_lshl_add_u32 v15, v20, 4, v15
    v_add_u32_e64 v15, s3, v15
    s_mul_i32 s3, s6, 160
    s_add_u32 s3, s3, 66560
    v_lshrrev_b32_e64 v19, 5, v1
    v_mul_u32_u24 v16, 80, v19
    v_bfe_u32 v19, v1, 1, 4
    v_lshl_add_u32 v16, v19, 2, v16
    v_and_b32_e64 v19, 1, v1
    v_mul_u32_u24 v19, 2624, v19
    v_add3_u32 v16, v16, v19, s3
    s_mov_b32 s75, 0
    s_mov_b32 exec_hi, 0
L_X_poll:
    global_load_dwordx2 v[124:125], v2, s[70:71] offset:0 sc1
    s_waitcnt vmcnt(0)
    v_cmp_eq_u64 vcc, v[124:125], v[126:127]
    s_and_b32 s8, vcc_lo, 0xffff
    s_cmp_eq_u32 s8, 0xffff
    s_cbranch_scc1 L_X_done
    s_lshr_b32 s3, vcc_lo, 16
    s_or_b32 s3, s3, s8
    s_cmp_eq_u32 s3, 0xffff
    s_cbranch_scc1 L_X_mixed
    s_add_u32 s75, s75, 1
    s_cmp_lg_u32 s75, 40
    s_cbranch_scc1 L_X_nowb
    buffer_wbl2 sc1
    s_waitcnt vmcnt(0)
    s_add_u32 s3, s11, 16
    s_lshl_b64 exec, 1, s3
    global_store_dwordx2 v2, v[126:127], s[70:71] offset:0 sc1
    s_mov_b64 exec, -1
    s_mov_b32 exec_hi, 0
L_X_nowb:
    s_cmp_lt_u32 s75, 0x100000
    s_cbranch_scc1 L_X_poll
L_X_mixed:
    s_cmp_ge_u32 s75, 40
    s_cbranch_scc1 L_X_didwb
    buffer_wbl2 sc1
    s_waitcnt vmcnt(0)
    s_add_u32 s3, s11, 16
    s_lshl_b64 exec, 1, s3
    global_store_dwordx2 v2, v[126:127], s[70:71] offset:0 sc1
    s_mov_b64 exec, -1
    s_mov_b32 exec_hi, 0
L_X_didwb:
    buffer_inv sc1
    s_waitcnt vmcnt(0)
L_X_done:
    s_mov_b64 exec, -1
L_B_join:
    s_barrier
    buffer_load_dwordx4 v14, s[56:59], 0 offen sc1 lds
    buffer_load_dwordx4 v14, s[56:59], 0 offen offset:1024 sc1 lds
    s_lshl_b32 s3, s6, 11
    s_add_u32 s12, s3, 107520
    s_movk_i32 s72, 15360
    s_lshl_b32 s13, s10, 7
    s_lshl_b32 s77, s6, 7
    s_add_u32 s77, s77, s66
    s_mov_b32 s60, s46
    s_mov_b32 s61, s47
    s_mov_b32 s62, 4718592
    s_mov_b32 s63, 0x20000
    s_cmp_lg_u32 s76, 7
    s_cbranch_scc1 L_B_havef
    ds_read_b64 v[128:129], v13 offset:0
    ds_read_b64 v[130:131], v13 offset:8
    ds_read_b64 v[132:133], v13 offset:64
    ds_read_b64 v[134:135], v13 offset:72
    ds_read_b64 v[136:137], v13 offset:128
    ds_read_b64 v[138:139], v13 offset:136
    ds_read_b64 v[140:141], v13 offset:192
    ds_read_b64 v[142:143], v13 offset:200
    ds_read_b64 v[144:145], v13 offset:512
    ds_read_b64 v[146:147], v13 offset:520
    ds_read_b64 v[148:149], v13 offset:576
    ds_read_b64 v[150:151], v13 offset:584
    ds_read_b64 v[152:153], v13 offset:640
    ds_read_b64 v[154:155], v13 offset:648
    ds_read_b64 v[156:157], v13 offset:704
    ds_read_b64 v[158:159], v13 offset:712
    ds_read_b64 v[160:161], v13 offset:1024
    ds_read_b64 v[162:163], v13 offset:1032
    ds_read_b64 v[164:165], v13 offset:1088
    ds_read_b64 v[166:167], v13 offset:1096
    ds_read_b64 v[168:169], v13 offset:1152
    ds_read_b64 v[170:171], v13 offset:1160
    ds_read_b64 v[172:173], v13 offset:1216
    ds_read_b64 v[174:175], v13 offset:1224
    ds_read_b64 v[176:177], v13 offset:1536
    ds_read_b64 v[178:179], v13 offset:1544
    ds_read_b64 v[180:181], v13 offset:1600
    ds_read_b64 v[182:183], v13 offset:1608
    ds_read_b64 v[184:185], v13 offset:1664
    ds_read_b64 v[186:187], v13 offset:1672
    ds_read_b64 v[188:189], v13 offset:1728
    ds_read_b64 v[190:191], v13 offset:1736
    ds_read_b64 v[192:193], v13 offset:2048
    ds_read_b64 v[194:195], v13 offset:2056
    ds_read_b64 v[196:197], v13 offset:2112
    ds_read_b64 v[198:199], v13 offset:2120
    ds_read_b64 v[200:201], v13 offset:2176
    ds_read_b64 v[202:203], v13 offset:2184
    ds_read_b64 v[204:205], v13 offset:2240
    ds_read_b64 v[206:207], v13 offset:2248
    ds_read_b64 v[208:209], v13 offset:2560
    ds_read_b64 v[210:211], v13 offset:2568
    ds_read_b64 v[212:213], v13 offset:2624
    ds_read_b64 v[214:215], v13 offset:2632
    ds_read_b64 v[216:217], v13 offset:2688
    ds_read_b64 v[218:219], v13 offset:2696
    ds_read_b64 v[220:221], v13 offset:2752
    ds_read_b64 v[222:223], v13 offset:2760
    ds_read_b64 v[224:225], v13 offset:3072
    ds_read_b64 v[226:227], v13 offset:3080
    ds_read_b64 v[228:229], v13 offset:3136
    ds_read_b64 v[230:231], v13 offset:3144
    ds_read_b64 v[232:233], v13 offset:3200
    ds_read_b64 v[234:235], v13 offset:3208
    ds_read_b64 v[236:237], v13 offset:3264
    ds_read_b64 v[238:239], v13 offset:3272
    ds_read_b64 v[240:241], v13 offset:3584
    ds_read_b64 v[242:243], v13 offset:3592
    ds_read_b64 v[244:245], v13 offset:3648
    ds_read_b64 v[246:247], v13 offset:3656
    ds_read_b64 v[248:249], v13 offset:3712
    ds_read_b64 v[250:251], v13 offset:3720
    ds_read_b64 v[252:253], v13 offset:3776
    ds_read_b64 v[254:255], v13 offset:3784
L_B_havef:
    s_waitcnt vmcnt(0)
    s_barrier
    ds_read_b128 v[36:39], v22 offset:0
    ds_read_b128 v[40:43], v23 offset:0
    ds_read_b128 v[44:47], v24 offset:0
    ds_read_b128 v[48:51], v25 offset:0
    s_waitcnt lgkmcnt(3)
    v_mfma_f32_16x16x32_bf16 v[68:71], v[128:131], v[36:39], 0
    ds_read_b128 v[52:55], v22 offset:2048
    ds_read_b128 v[56:59], v23 offset:2048
    ds_read_b128 v[60:63], v24 offset:2048
    s_waitcnt lgkmcnt(5)
    v_mfma_f32_16x16x32_bf16 v[68:71], v[132:135], v[40:43], v[68:71]
    ds_read_b128 v[64:67], v25 offset:2048
    global_load_dwordx4 v[28:31], v18, s[34:35] offset:0
    global_load_dwordx4 v[32:35], v18, s[34:35] offset:1152
    s_waitcnt lgkmcnt(5)
    v_mfma_f32_16x16x32_bf16 v[68:71], v[136:139], v[44:47], v[68:71]
    s_waitcnt lgkmcnt(4)
    v_mfma_f32_16x16x32_bf16 v[68:71], v[140:143], v[48:51], v[68:71]
    v_mfma_f32_16x16x32_bf16 v[72:75], v[144:147], v[36:39], 0
    v_mfma_f32_16x16x32_bf16 v[72:75], v[148:151], v[40:43], v[72:75]
    v_mfma_f32_16x16x32_bf16 v[72:75], v[152:155], v[44:47], v[72:75]
    v_mfma_f32_16x16x32_bf16 v[72:75], v[156:159], v[48:51], v[72:75]
    v_mfma_f32_16x16x32_bf16 v[76:79], v[160:163], v[36:39], 0
    v_mfma_f32_16x16x32_bf16 v[76:79], v[164:167], v[40:43], v[76:79]
    v_mfma_f32_16x16x32_bf16 v[76:79], v[168:171], v[44:47], v[76:79]
    v_mfma_f32_16x16x32_bf16 v[76:79], v[172:175], v[48:51], v[76:79]
    ds_write_b128 v15, v[68:71] offset:0
    v_mfma_f32_16x16x32_bf16 v[80:83], v[176:179], v[36:39], 0
    v_mfma_f32_16x16x32_bf16 v[80:83], v[180:183], v[40:43], v[80:83]
    v_mfma_f32_16x16x32_bf16 v[80:83], v[184:187], v[44:47], v[80:83]
    v_mfma_f32_16x16x32_bf16 v[80:83], v[188:191], v[48:51], v[80:83]
    v_mfma_f32_16x16x32_bf16 v[84:87], v[192:195], v[36:39], 0
    v_mfma_f32_16x16x32_bf16 v[84:87], v[196:199], v[40:43], v[84:87]
    v_mfma_f32_16x16x32_bf16 v[84:87], v[200:203], v[44:47], v[84:87]
    v_mfma_f32_16x16x32_bf16 v[84:87], v[204:207], v[48:51], v[84:87]
    v_mfma_f32_16x16x32_bf16 v[88:91], v[208:211], v[36:39], 0
    v_mfma_f32_16x16x32_bf16 v[88:91], v[212:215], v[40:43], v[88:91]
    v_mfma_f32_16x16x32_bf16 v[88:91], v[216:219], v[44:47], v[88:91]
    v_mfma_f32_16x16x32_bf16 v[88:91], v[220:223], v[48:51], v[88:91]
    v_mfma_f32_16x16x32_bf16 v[92:95], v[224:227], v[36:39], 0
    v_mfma_f32_16x16x32_bf16 v[92:95], v[228:231], v[40:43], v[92:95]
    v_mfma_f32_16x16x32_bf16 v[92:95], v[232:235], v[44:47], v[92:95]
    v_mfma_f32_16x16x32_bf16 v[92:95], v[236:239], v[48:51], v[92:95]
    v_mfma_f32_16x16x32_bf16 v[96:99], v[240:243], v[36:39], 0
    ds_read_b128 v[36:39], v22 offset:4096
    v_mfma_f32_16x16x32_bf16 v[96:99], v[244:247], v[40:43], v[96:99]
    ds_read_b128 v[40:43], v23 offset:4096
    v_mfma_f32_16x16x32_bf16 v[96:99], v[248:251], v[44:47], v[96:99]
    ds_read_b128 v[44:47], v24 offset:4096
    v_mfma_f32_16x16x32_bf16 v[96:99], v[252:255], v[48:51], v[96:99]
    ds_read_b128 v[48:51], v25 offset:4096
    s_waitcnt lgkmcnt(4)
    v_mfma_f32_16x16x32_bf16 v[72:75], v[128:131], v[52:55], v[72:75]
    v_mfma_f32_16x16x32_bf16 v[72:75], v[132:135], v[56:59], v[72:75]
    v_mfma_f32_16x16x32_bf16 v[72:75], v[136:139], v[60:63], v[72:75]
    v_mfma_f32_16x16x32_bf16 v[72:75], v[140:143], v[64:67], v[72:75]
    v_mfma_f32_16x16x32_bf16 v[76:79], v[144:147], v[52:55], v[76:79]
    v_mfma_f32_16x16x32_bf16 v[76:79], v[148:151], v[56:59], v[76:79]
    v_mfma_f32_16x16x32_bf16 v[76:79], v[152:155], v[60:63], v[76:79]
    v_mfma_f32_16x16x32_bf16 v[76:79], v[156:159], v[64:67], v[76:79]
    v_mfma_f32_16x16x32_bf16 v[80:83], v[160:163], v[52:55], v[80:83]
    v_mfma_f32_16x16x32_bf16 v[80:83], v[164:167], v[56:59], v[80:83]
    v_mfma_f32_16x16x32_bf16 v[80:83], v[168:171], v[60:63], v[80:83]
    v_mfma_f32_16x16x32_bf16 v[80:83], v[172:175], v[64:67], v[80:83]
    ds_write_b128 v15, v[72:75] offset:10752
    v_mfma_f32_16x16x32_bf16 v[84:87], v[176:179], v[52:55], v[84:87]
    v_mfma_f32_16x16x32_bf16 v[84:87], v[180:183], v[56:59], v[84:87]
    v_mfma_f32_16x16x32_bf16 v[84:87], v[184:187], v[60:63], v[84:87]
    v_mfma_f32_16x16x32_bf16 v[84:87], v[188:191], v[64:67], v[84:87]
    v_mfma_f32_16x16x32_bf16 v[88:91], v[192:195], v[52:55], v[88:91]
    v_mfma_f32_16x16x32_bf16 v[88:91], v[196:199], v[56:59], v[88:91]
    v_mfma_f32_16x16x32_bf16 v[88:91], v[200:203], v[60:63], v[88:91]
    v_mfma_f32_16x16x32_bf16 v[88:91], v[204:207], v[64:67], v[88:91]
    v_mfma_f32_16x16x32_bf16 v[92:95], v[208:211], v[52:55], v[92:95]
    v_mfma_f32_16x16x32_bf16 v[92:95], v[212:215], v[56:59], v[92:95]
    v_mfma_f32_16x16x32_bf16 v[92:95], v[216:219], v[60:63], v[92:95]
    v_mfma_f32_16x16x32_bf16 v[92:95], v[220:223], v[64:67], v[92:95]
    v_mfma_f32_16x16x32_bf16 v[96:99], v[224:227], v[52:55], v[96:99]
    ds_read_b128 v[52:55], v22 offset:6144
    v_bfe_u32 v227, v1, 2, 3
    v_lshlrev_b32 v225, 15, v227
    v_lshrrev_b32_e64 v227, 5, v1
    v_mfma_f32_16x16x32_bf16 v[96:99], v[228:231], v[56:59], v[96:99]
    ds_read_b128 v[56:59], v23 offset:6144
    v_lshl_add_u32 v225, v227, 6, v225
    v_lshlrev_b32 v226, 9, v227
    v_and_b32 v227, 3, v1
    v_mfma_f32_16x16x32_bf16 v[96:99], v[232:235], v[60:63], v[96:99]
    ds_read_b128 v[60:63], v24 offset:6144
    v_lshl_add_u32 v225, v227, 4, v225
    v_add_u32 v225, s77, v225
    v_and_b32 v227, 7, v1
    v_mfma_f32_16x16x32_bf16 v[96:99], v[236:239], v[64:67], v[96:99]
    ds_read_b128 v[64:67], v25 offset:6144
    v_lshl_add_u32 v226, v227, 6, v226
    v_lshl_add_u32 v227, v227, 4, s13
    s_waitcnt lgkmcnt(3)
    v_mfma_f32_16x16x32_bf16 v[76:79], v[128:131], v[36:39], v[76:79]
    v_lshlrev_b32 v224, 1, v18
    v_sub_u32_e64 v224, v224, v227
    v_add_u32 v224, 1152, v224
    v_bfe_u32 v227, v1, 3, 2
    v_mfma_f32_16x16x32_bf16 v[76:79], v[132:135], v[40:43], v[76:79]
    v_lshl_add_u32 v226, v227, 4, v226
    v_add_u32_e64 v226, s12, v226
    v_mfma_f32_16x16x32_bf16 v[76:79], v[136:139], v[44:47], v[76:79]
    v_mfma_f32_16x16x32_bf16 v[76:79], v[140:143], v[48:51], v[76:79]
    v_mfma_f32_16x16x32_bf16 v[80:83], v[144:147], v[36:39], v[80:83]
    v_mfma_f32_16x16x32_bf16 v[80:83], v[148:151], v[40:43], v[80:83]
    v_mfma_f32_16x16x32_bf16 v[80:83], v[152:155], v[44:47], v[80:83]
    v_mfma_f32_16x16x32_bf16 v[80:83], v[156:159], v[48:51], v[80:83]
    v_mfma_f32_16x16x32_bf16 v[84:87], v[160:163], v[36:39], v[84:87]
    v_mfma_f32_16x16x32_bf16 v[84:87], v[164:167], v[40:43], v[84:87]
    v_mfma_f32_16x16x32_bf16 v[84:87], v[168:171], v[44:47], v[84:87]
    v_mfma_f32_16x16x32_bf16 v[84:87], v[172:175], v[48:51], v[84:87]
    ds_write_b128 v15, v[76:79] offset:21504
    v_subrev_u32 v15, 66560, v15
    v_mfma_f32_16x16x32_bf16 v[88:91], v[176:179], v[36:39], v[88:91]
    v_mfma_f32_16x16x32_bf16 v[88:91], v[180:183], v[40:43], v[88:91]
    v_mfma_f32_16x16x32_bf16 v[88:91], v[184:187], v[44:47], v[88:91]
    v_mfma_f32_16x16x32_bf16 v[88:91], v[188:191], v[48:51], v[88:91]
    v_mfma_f32_16x16x32_bf16 v[92:95], v[192:195], v[36:39], v[92:95]
    s_waitcnt lgkmcnt(0)
    s_barrier
    ds_read2st64_b32 v[100:101], v16 offset0:0 offset1:21
    ds_read2st64_b32 v[102:103], v16 offset0:5 offset1:26
    v_mfma_f32_16x16x32_bf16 v[92:95], v[196:199], v[40:43], v[92:95]
    ds_read2st64_b32 v[104:105], v16 offset0:42 offset1:63
    ds_read2st64_b32 v[106:107], v16 offset0:47 offset1:68
    v_mfma_f32_16x16x32_bf16 v[92:95], v[200:203], v[44:47], v[92:95]
    v_mfma_f32_16x16x32_bf16 v[92:95], v[204:207], v[48:51], v[92:95]
    v_mfma_f32_16x16x32_bf16 v[96:99], v[208:211], v[36:39], v[96:99]
    ds_read_b128 v[36:39], v22 offset:8192
    v_mfma_f32_16x16x32_bf16 v[96:99], v[212:215], v[40:43], v[96:99]
    ds_read_b128 v[40:43], v23 offset:8192
    s_waitcnt lgkmcnt(4)
    v_add_f32 v100, v100, v101
    v_add_f32_e64 v102, v102, v103
    v_mfma_f32_16x16x32_bf16 v[96:99], v[216:219], v[44:47], v[96:99]
    ds_read_b128 v[44:47], v24 offset:8192
    v_cvt_pk_bf16_f32 v100, v100, v102
    buffer_store_dword v100, v17, s[56:59], s73 offen
    s_waitcnt lgkmcnt(3)
    v_add_f32 v104, v104, v105
    v_mfma_f32_16x16x32_bf16 v[96:99], v[220:223], v[48:51], v[96:99]
    ds_read_b128 v[48:51], v25 offset:8192
    v_add_f32_e64 v106, v106, v107
    v_cvt_pk_bf16_f32 v104, v104, v106
    v_mfma_f32_16x16x32_bf16 v[80:83], v[128:131], v[52:55], v[80:83]
    buffer_store_dword v104, v17, s[56:59], s73 offen offset:2048
    s_add_u32 s73, s73, 4096
    ds_read2st64_b32 v[100:101], v16 offset0:84 offset1:105
    ds_read2st64_b32 v[102:103], v16 offset0:89 offset1:110
    v_mfma_f32_16x16x32_bf16 v[80:83], v[132:135], v[56:59], v[80:83]
    v_subrev_u32 v16, 66560, v16
    v_mfma_f32_16x16x32_bf16 v[80:83], v[136:139], v[60:63], v[80:83]
    v_mfma_f32_16x16x32_bf16 v[80:83], v[140:143], v[64:67], v[80:83]
    v_mfma_f32_16x16x32_bf16 v[84:87], v[144:147], v[52:55], v[84:87]
    v_mfma_f32_16x16x32_bf16 v[84:87], v[148:151], v[56:59], v[84:87]
    s_waitcnt lgkmcnt(0)
    v_add_f32 v100, v100, v101
    v_add_f32_e64 v102, v102, v103
    v_mfma_f32_16x16x32_bf16 v[84:87], v[152:155], v[60:63], v[84:87]
    v_cvt_pk_bf16_f32 v100, v100, v102
    buffer_store_dword v100, v17, s[56:59], s73 offen
    ds_write_b128 v15, v[80:83] offset:0
    v_mfma_f32_16x16x32_bf16 v[84:87], v[156:159], v[64:67], v[84:87]
    v_mfma_f32_16x16x32_bf16 v[88:91], v[160:163], v[52:55], v[88:91]
    v_mfma_f32_16x16x32_bf16 v[88:91], v[164:167], v[56:59], v[88:91]
    v_mfma_f32_16x16x32_bf16 v[88:91], v[168:171], v[60:63], v[88:91]
    v_mfma_f32_16x16x32_bf16 v[88:91], v[172:175], v[64:67], v[88:91]
    v_mfma_f32_16x16x32_bf16 v[92:95], v[176:179], v[52:55], v[92:95]
    v_mfma_f32_16x16x32_bf16 v[92:95], v[180:183], v[56:59], v[92:95]
    v_mfma_f32_16x16x32_bf16 v[92:95], v[184:187], v[60:63], v[92:95]
    v_mfma_f32_16x16x32_bf16 v[92:95], v[188:191], v[64:67], v[92:95]
    v_mfma_f32_16x16x32_bf16 v[96:99], v[192:195], v[52:55], v[96:99]
    ds_read_b128 v[52:55], v22 offset:10240
    v_mfma_f32_16x16x32_bf16 v[96:99], v[196:199], v[56:59], v[96:99]
    ds_read_b128 v[56:59], v23 offset:10240
    v_mfma_f32_16x16x32_bf16 v[96:99], v[200:203], v[60:63], v[96:99]
    ds_read_b128 v[60:63], v24 offset:10240
    v_mfma_f32_16x16x32_bf16 v[96:99], v[204:207], v[64:67], v[96:99]
    ds_read_b128 v[64:67], v25 offset:10240
    v_mfma_f32_16x16x32_bf16 v[84:87], v[128:131], v[36:39], v[84:87]
    v_mfma_f32_16x16x32_bf16 v[84:87], v[132:135], v[40:43], v[84:87]
    v_mfma_f32_16x16x32_bf16 v[84:87], v[136:139], v[44:47], v[84:87]
    v_mfma_f32_16x16x32_bf16 v[84:87], v[140:143], v[48:51], v[84:87]
    v_mfma_f32_16x16x32_bf16 v[88:91], v[144:147], v[36:39], v[88:91]
    v_mfma_f32_16x16x32_bf16 v[88:91], v[148:151], v[40:43], v[88:91]
    v_mfma_f32_16x16x32_bf16 v[88:91], v[152:155], v[44:47], v[88:91]
    v_mfma_f32_16x16x32_bf16 v[88:91], v[156:159], v[48:51], v[88:91]
    s_waitcnt vmcnt(3)
    v_lshlrev_b32 v240, 16, v28
    v_and_b32 v241, s67, v28
    v_lshlrev_b32 v242, 16, v29
    v_mfma_f32_16x16x32_bf16 v[92:95], v[160:163], v[36:39], v[92:95]
    ds_write_b128 v15, v[84:87] offset:10752
    v_and_b32 v243, s67, v29
    v_lshlrev_b32 v244, 16, v30
    v_and_b32 v245, s67, v30
    v_mfma_f32_16x16x32_bf16 v[92:95], v[164:167], v[40:43], v[92:95]
    v_lshlrev_b32 v246, 16, v31
    v_and_b32 v247, s67, v31
    v_lshlrev_b32 v248, 16, v32
    v_and_b32 v249, s67, v32
    v_mfma_f32_16x16x32_bf16 v[92:95], v[168:171], v[44:47], v[92:95]
    v_lshlrev_b32 v250, 16, v33
    v_and_b32 v251, s67, v33
    v_lshlrev_b32 v252, 16, v34
    v_and_b32 v253, s67, v34
    v_mfma_f32_16x16x32_bf16 v[92:95], v[172:175], v[48:51], v[92:95]
    v_lshlrev_b32 v254, 16, v35
    v_and_b32_e64 v255, s67, v35
    v_mfma_f32_16x16x32_bf16 v[96:99], v[176:179], v[36:39], v[96:99]
    ds_read_b128 v[36:39], v22 offset:12288
    v_mfma_f32_16x16x32_bf16 v[96:99], v[180:183], v[40:43], v[96:99]
    ds_read_b128 v[40:43], v23 offset:12288
    v_mfma_f32_16x16x32_bf16 v[96:99], v[184:187], v[44:47], v[96:99]
    ds_read_b128 v[44:47], v24 offset:12288
    v_mfma_f32_16x16x32_bf16 v[96:99], v[188:191], v[48:51], v[96:99]
    ds_read_b128 v[48:51], v25 offset:12288
    s_waitcnt lgkmcnt(4)
    v_mfma_f32_16x16x32_bf16 v[88:91], v[128:131], v[52:55], v[88:91]
    v_mfma_f32_16x16x32_bf16 v[88:91], v[132:135], v[56:59], v[88:91]
    v_mfma_f32_16x16x32_bf16 v[88:91], v[136:139], v[60:63], v[88:91]
    v_mfma_f32_16x16x32_bf16 v[88:91], v[140:143], v[64:67], v[88:91]
    v_mfma_f32_16x16x32_bf16 v[92:95], v[144:147], v[52:55], v[92:95]
    v_mfma_f32_16x16x32_bf16 v[92:95], v[148:151], v[56:59], v[92:95]
    v_mfma_f32_16x16x32_bf16 v[92:95], v[152:155], v[60:63], v[92:95]
    v_mfma_f32_16x16x32_bf16 v[92:95], v[156:159], v[64:67], v[92:95]
    v_mfma_f32_16x16x32_bf16 v[96:99], v[160:163], v[52:55], v[96:99]
    ds_read_b128 v[52:55], v22 offset:14336
    v_mfma_f32_16x16x32_bf16 v[96:99], v[164:167], v[56:59], v[96:99]
    ds_read_b128 v[56:59], v23 offset:14336
    ds_write_b128 v15, v[88:91] offset:21504
    v_mfma_f32_16x16x32_bf16 v[96:99], v[168:171], v[60:63], v[96:99]
    ds_read_b128 v[60:63], v24 offset:14336
    v_mfma_f32_16x16x32_bf16 v[96:99], v[172:175], v[64:67], v[96:99]
    ds_read_b128 v[64:67], v25 offset:14336
    s_waitcnt lgkmcnt(5)
    v_mfma_f32_16x16x32_bf16 v[92:95], v[128:131], v[36:39], v[92:95]
    v_mfma_f32_16x16x32_bf16 v[92:95], v[132:135], v[40:43], v[92:95]
    v_mfma_f32_16x16x32_bf16 v[92:95], v[136:139], v[44:47], v[92:95]
    s_waitcnt lgkmcnt(2)
    s_barrier
    ds_read2st64_b32 v[104:105], v16 offset0:0 offset1:21
    ds_read2st64_b32 v[106:107], v16 offset0:5 offset1:26
    v_mfma_f32_16x16x32_bf16 v[92:95], v[140:143], v[48:51], v[92:95]
    ds_read2st64_b32 v[100:101], v16 offset0:42 offset1:63
    ds_read2st64_b32 v[102:103], v16 offset0:47 offset1:68
    v_mfma_f32_16x16x32_bf16 v[96:99], v[144:147], v[36:39], v[96:99]
    v_mfma_f32_16x16x32_bf16 v[96:99], v[148:151], v[40:43], v[96:99]
    v_mfma_f32_16x16x32_bf16 v[96:99], v[152:155], v[44:47], v[96:99]
    v_mfma_f32_16x16x32_bf16 v[96:99], v[156:159], v[48:51], v[96:99]
    s_waitcnt lgkmcnt(2)
    v_add_f32 v104, v104, v105
    v_add_f32_e64 v106, v106, v107
    v_mfma_f32_16x16x32_bf16 v[96:99], v[128:131], v[52:55], v[96:99]
    v_cvt_pk_bf16_f32 v104, v104, v106
    buffer_store_dword v104, v17, s[56:59], s73 offen offset:2048
    s_add_u32 s73, s73, 4096
    s_waitcnt lgkmcnt(0)
    v_add_f32 v100, v100, v101
    v_mfma_f32_16x16x32_bf16 v[96:99], v[132:135], v[56:59], v[96:99]
    v_add_f32_e64 v102, v102, v103
    v_cvt_pk_bf16_f32 v100, v100, v102
    buffer_store_dword v100, v17, s[56:59], s73 offen
    v_mfma_f32_16x16x32_bf16 v[96:99], v[136:139], v[60:63], v[96:99]
    ds_read2st64_b32 v[104:105], v16 offset0:84 offset1:105
    ds_read2st64_b32 v[106:107], v16 offset0:89 offset1:110
    ds_write_b128 v15, v[92:95] offset:32256
    v_mfma_f32_16x16x32_bf16 v[96:99], v[140:143], v[64:67], v[96:99]
    s_waitcnt lgkmcnt(1)
    v_add_f32 v104, v104, v105
    v_add_f32_e64 v106, v106, v107
    v_cvt_pk_bf16_f32 v104, v104, v106
    buffer_store_dword v104, v17, s[56:59], s73 offen offset:2048
    s_add_u32 s73, s73, 4096
    s_nop 1
    ds_write_b128 v15, v[96:99] offset:43008
    s_waitcnt lgkmcnt(0)
    s_barrier
    ds_read2st64_b32 v[100:101], v16 offset0:126 offset1:147
    ds_read2st64_b32 v[102:103], v16 offset0:131 offset1:152
    s_waitcnt lgkmcnt(0)
    v_add_f32 v100, v100, v101
    v_add_f32 v102, v102, v103
    v_cvt_pk_bf16_f32 v100, v100, v102
    buffer_store_dword v100, v17, s[56:59], s73 offen
    ds_read2st64_b32 v[104:105], v16 offset0:168 offset1:189
    ds_read2st64_b32 v[106:107], v16 offset0:173 offset1:194
    s_waitcnt lgkmcnt(0)
    v_add_f32 v104, v104, v105
    v_add_f32_e64 v106, v106, v107
    v_cvt_pk_bf16_f32 v104, v104, v106
    buffer_store_dword v104, v17, s[56:59], s73 offen offset:2048
    s_add_u32 s73, s73, 4096
    s_mov_b32 m0, s12
    s_waitcnt vmcnt(0)
    s_barrier
    s_cmp_lg_u32 s76, 7
    s_cbranch_scc1 L_B_go2
    s_lshl_b64 exec, 1, s11
    global_store_dwordx2 v2, v[126:127], s[70:71] offset:256
    s_mov_b64 exec, -1
    s_mov_b32 s75, 0
    s_mov_b32 exec_hi, 0
L_Y_poll:
    global_load_dwordx2 v[124:125], v2, s[70:71] offset:256 sc1
    s_waitcnt vmcnt(0)
    v_cmp_eq_u64 vcc, v[124:125], v[126:127]
    s_and_b32 s8, vcc_lo, 0xffff
    s_cmp_eq_u32 s8, 0xffff
    s_cbranch_scc1 L_Y_done
    s_lshr_b32 s3, vcc_lo, 16
    s_or_b32 s3, s3, s8
    s_cmp_eq_u32 s3, 0xffff
    s_cbranch_scc1 L_Y_mixed
    s_add_u32 s75, s75, 1
    s_cmp_lg_u32 s75, 40
    s_cbranch_scc1 L_Y_nowb
    buffer_wbl2 sc1
    s_waitcnt vmcnt(0)
    s_add_u32 s3, s11, 16
    s_lshl_b64 exec, 1, s3
    global_store_dwordx2 v2, v[126:127], s[70:71] offset:256 sc1
    s_mov_b64 exec, -1
    s_mov_b32 exec_hi, 0
L_Y_nowb:
    s_cmp_lt_u32 s75, 0x100000
    s_cbranch_scc1 L_Y_poll
L_Y_mixed:
    s_cmp_ge_u32 s75, 40
    s_cbranch_scc1 L_Y_didwb
    buffer_wbl2 sc1
    s_waitcnt vmcnt(0)
    s_add_u32 s3, s11, 16
    s_lshl_b64 exec, 1, s3
    global_store_dwordx2 v2, v[126:127], s[70:71] offset:256 sc1
    s_mov_b64 exec, -1
    s_mov_b32 exec_hi, 0
L_Y_didwb:
    buffer_inv sc1
    s_waitcnt vmcnt(0)
L_Y_done:
    s_mov_b64 exec, -1
L_B_go2:
    s_barrier
    buffer_load_dwordx4 v225, s[56:59], 0 offen sc1 lds
    buffer_load_dwordx4 v225, s[56:59], s72 offen offset:1024 sc1 lds
    s_waitcnt vmcnt(1)
    ds_read_b128 v[128:131], v226
    s_waitcnt vmcnt(0)
    ds_read_b128 v[132:135], v226 offset:1024
    s_waitcnt lgkmcnt(1)
    v_lshlrev_b32 v136, 16, v128
    v_and_b32 v137, s67, v128
    v_pk_mul_f32 v[136:137], v[136:137], v[240:241]
    v_lshlrev_b32 v138, 16, v129
    v_and_b32 v139, s67, v129
    v_pk_mul_f32 v[138:139], v[138:139], v[242:243]
    v_lshlrev_b32 v140, 16, v130
    v_and_b32 v141, s67, v130
    v_pk_mul_f32 v[140:141], v[140:141], v[248:249]
    v_lshlrev_b32 v142, 16, v131
    v_and_b32_e64 v143, s67, v131
    v_pk_mul_f32 v[142:143], v[142:143], v[250:251]
    v_cvt_pk_bf16_f32 v152, v136, v137
    v_cvt_pk_bf16_f32 v153, v138, v139
    v_cvt_pk_bf16_f32 v156, v140, v141
    v_cvt_pk_bf16_f32 v157, v142, v143
    s_waitcnt lgkmcnt(0)
    v_lshlrev_b32 v144, 16, v132
    v_and_b32 v145, s67, v132
    v_pk_mul_f32 v[144:145], v[144:145], v[244:245]
    v_lshlrev_b32 v146, 16, v133
    v_and_b32 v147, s67, v133
    v_pk_mul_f32 v[146:147], v[146:147], v[246:247]
    v_lshlrev_b32 v148, 16, v134
    v_and_b32 v149, s67, v134
    v_pk_mul_f32 v[148:149], v[148:149], v[252:253]
    v_lshlrev_b32 v150, 16, v135
    v_and_b32_e64 v151, s67, v135
    v_pk_mul_f32 v[150:151], v[150:151], v[254:255]
    v_cvt_pk_bf16_f32 v154, v144, v145
    v_cvt_pk_bf16_f32 v155, v146, v147
    v_cvt_pk_bf16_f32 v158, v148, v149
    v_cvt_pk_bf16_f32 v159, v150, v151
    buffer_store_dwordx4 v[152:155], v224, s[60:63], 0 offen offset:0 sc1
    buffer_store_dwordx4 v[156:159], v224, s[60:63], 0 offen offset:2304 sc1
    s_endpgm
L_end:
    s_endpgm
.section .rodata,"a"
.p2align 6
.amdhsa_kernel concat_heads__ssm_conv_s4__ssm_conv_h3__prompt_kernel
  .amdhsa_next_free_vgpr 256
  .amdhsa_next_free_sgpr 102
  .amdhsa_accum_offset 256
  .amdhsa_group_segment_fixed_size 0
  .amdhsa_kernarg_size 144
  .amdhsa_user_sgpr_count 2
  .amdhsa_user_sgpr_kernarg_segment_ptr 1
  .amdhsa_system_sgpr_workgroup_id_x 1
.end_amdhsa_kernel
```
